```python
import torch

def _softmax(x, axis=-1):
    return torch.softmax(x, dim=axis)

def _gelu(x):
    return torch.nn.functional.gelu(x, approximate='tanh')

def _silu(x):
    return torch.nn.functional.silu(x)

def _sigmoid(x):
    return torch.sigmoid(x)

def _layernorm(x, axis=-1, eps=1e-05):
    m = x.mean(dim=axis, keepdim=True)
    v = x.var(dim=axis, keepdim=True, unbiased=False)
    return (x - m) / torch.sqrt(v + eps)

def _scatter_add(tgt, idx, src, axis=0):
    return tgt.clone().index_add_(axis, idx, src)

def _segment_sum(src, seg, n):
    out = torch.zeros((n,) + src.shape[1:], dtype=src.dtype)
    return out.index_add_(0, seg, src)

def _pad(x, pw):
    flat = tuple((v for pair in reversed(pw) for v in pair))
    return torch.nn.functional.pad(x, flat)
kernel_name = 'adaLN_cond__sliding_block_cached__geglu_ffn__decode'

def setup_inputs():

    _w = lambda a: (lambda t: t.to(torch.bfloat16) if t.is_floating_point() else t)(torch.as_tensor(a))

    def _A_setup():
        B, Sq, D = (1, 1, 1024)
        Hq, Hkv, Sk, Dh = (32, 4, 65536, 128)
        assert Hq % Hkv == 0, (Hq, Hkv)
        return {'x': _w((lambda *s: torch.randn(*s, dtype=torch.bfloat16) * 0.05)(B, Sq, D)), 'k_cache': _w((lambda *s: torch.randn(*s, dtype=torch.bfloat16) * 3.2)(B, Hkv, Sk, Dh)), 'v_cache': _w((lambda *s: torch.randn(*s, dtype=torch.bfloat16) * 0.4)(B, Hkv, Sk, Dh)), 'wq': _w((lambda *s: torch.randn(*s, dtype=torch.bfloat16) * 3.2)(D, Hq * Dh) * D ** (-0.5)), 'wo': _w((lambda *s: torch.randn(*s, dtype=torch.bfloat16) * 0.4)(Hq * Dh, D) * (Hq * Dh) ** (-0.5))}
    _A_in = _A_setup()

    def _B_setup():
        B, S, D, F = (1, 1, 1024, 3584)
        return {'x': _w((lambda *s: torch.randn(*s, dtype=torch.bfloat16) * 0.05)(B, S, D)), 'w_gate': _w((lambda *s: torch.randn(*s, dtype=torch.bfloat16) * 0.05)(D, F)), 'w_up': _w((lambda *s: torch.randn(*s, dtype=torch.bfloat16) * 0.05)(D, F)), 'w_down': _w((lambda *s: torch.randn(*s, dtype=torch.bfloat16) * 0.05)(F, D))}
    _B_in = _B_setup()
    return {'A_x': _A_in['x'], 'A_k_cache': _A_in['k_cache'], 'A_v_cache': _A_in['v_cache'], 'A_wq': _A_in['wq'], 'A_wo': _A_in['wo'], 'B_x': _B_in['x'], 'B_w_gate': _B_in['w_gate'], 'B_w_up': _B_in['w_up'], 'B_w_down': _B_in['w_down'], 'c': _w((lambda *s: torch.randn(*s, dtype=torch.bfloat16) * 0.2)(1, 1024) * 8.0), 'w_mod': _w((lambda *s: torch.randn(*s, dtype=torch.bfloat16) * 0.2)(1024, 6 * 1024) * 1024 ** (-0.5) * 8.0)}

def reference(A_x, A_k_cache, A_v_cache, A_wq, A_wo, B_x, B_w_gate, B_w_up, B_w_down, c, w_mod):

    def _A_ref(x, k_cache, v_cache, wq, wo):
        B, Sq, D = x.shape
        Hq, Dh = (32, 128)
        Hkv, Sk = (k_cache.shape[1], k_cache.shape[2])
        W = min(4096, max(256, Sk // 4))
        rep = Hq // Hkv
        q = (lambda x, *d: x.permute(*d))((x @ wq).reshape(B, Sq, Hq, Dh), 0, 2, 1, 3)
        k = (lambda x, n, axis: torch.repeat_interleave(x, n, dim=axis))(k_cache[:, :, Sk - W:, :], rep, axis=1)
        v = (lambda x, n, axis: torch.repeat_interleave(x, n, dim=axis))(v_cache[:, :, Sk - W:, :], rep, axis=1)
        scores = torch.einsum('bhqd,bhkd->bhqk', q, k) * Dh ** (-0.5)
        p = _softmax(scores, axis=-1)
        o = torch.einsum('bhqk,bhkd->bhqd', p, v)
        return (lambda x, *d: x.permute(*d))(o, 0, 2, 1, 3).reshape(B, Sq, Hq * Dh) @ wo

    def _B_ref(x, w_gate, w_up, w_down):
        return _gelu(x @ w_gate) * (x @ w_up) @ w_down
    x = A_x
    mod = (_silu(c) @ w_mod).reshape(c.shape[0], 6, 1, -1)
    sa, ca, ga, sb, cb, gb = (mod[:, 0].clone(), mod[:, 1].clone(), mod[:, 2].clone(), mod[:, 3].clone(), mod[:, 4].clone(), mod[:, 5].clone())
    h = _layernorm(x, axis=-1) * (1 + ca) + sa
    x = x + ga * _A_ref(h, A_k_cache, A_v_cache, A_wq, A_wo)
    h = _layernorm(x, axis=-1) * (1 + cb) + sb
    x = x + gb * _B_ref(h, B_w_gate, B_w_up, B_w_down)
    return x
```

```asm
; @launch grid=(256,1,1) block=(1024,1,1) lds=42496
.amdgcn_target "amdgcn-amd-amdhsa--gfx950"
.text
.globl adaLN_cond__sliding_block_cached__geglu_ffn__decode_kernel
.p2align 8
.type adaLN_cond__sliding_block_cached__geglu_ffn__decode_kernel,@function
adaLN_cond__sliding_block_cached__geglu_ffn__decode_kernel:
s_cmp_ge_u32 s2, 256
s_cbranch_scc1 EXIT
s_load_dwordx16 s[4:19], s[0:1], 0
s_load_dwordx8 s[20:27], s[0:1], 64
s_load_dwordx4 s[28:31], s[0:1], 96
v_lshrrev_b32 v1, 6, v0
v_and_b32 v0, 63, v0
v_mov_b32 v2, 1
v_readfirstlane_b32 s3, v1
v_mov_b32 v1, 0
v_mov_b32 v3, 0xffffff00
v_lshlrev_b32 v5, 4, v0
s_mov_b32 s41, 0x0c0c0400
s_mov_b32 s42, 0x04000c0c
s_mov_b32 s43, 0x4000000
s_and_b32 s34, s3, 3
s_lshr_b32 s32, s3, 2
s_lshl_b32 s33, s34, 2
v_mov_b32 v7, s33
s_waitcnt lgkmcnt(0)
s_load_dword s35, s[30:31], 0
s_cmp_eq_u32 s32, 2
s_cbranch_scc1 G1
s_cmp_eq_u32 s32, 3
s_cbranch_scc1 G2
s_cmp_eq_u32 s32, 1
s_cbranch_scc1 G3
v_lshrrev_b32 v8, 3, v0
v_and_b32 v9, 7, v0
v_lshlrev_b32 v9, 4, v9
s_and_b32 s44, s2, 31
s_lshr_b32 s45, s2, 5
s_lshl_b32 s45, s45, 7
s_lshl_b32 s46, s34, 5
s_add_u32 s45, s45, s46
s_lshl_b32 s46, s45, 1
s_add_u32 s22, s22, s46
s_addc_u32 s23, s23, 0
v_lshlrev_b32 v10, 3, v8
global_load_dwordx2 v[24:25], v10, s[22:23]
s_mul_i32 s46, s45, 12288
s_lshl_b32 s47, s44, 7
s_add_u32 s46, s46, s47
s_add_u32 s24, s24, s46
s_addc_u32 s25, s25, 0
v_mul_u32_u24 v10, 49152, v8
v_add_u32 v10, v10, v9
global_load_dwordx4 v[48:51], v10, s[24:25] nt
s_add_u32 s24, s24, 12288
s_addc_u32 s25, s25, 0
global_load_dwordx4 v[52:55], v10, s[24:25] nt
s_add_u32 s24, s24, 12288
s_addc_u32 s25, s25, 0
global_load_dwordx4 v[56:59], v10, s[24:25] nt
s_add_u32 s24, s24, 12288
s_addc_u32 s25, s25, 0
global_load_dwordx4 v[60:63], v10, s[24:25] nt
s_lshr_b32 s46, s2, 2
s_and_b32 s47, s2, 3
s_lshl_b32 s48, s47, 8
s_lshl_b32 s49, s34, 6
s_add_u32 s48, s48, s49
s_lshl_b32 s48, s48, 13
s_lshl_b32 s49, s46, 7
s_add_u32 s48, s48, s49
s_add_u32 s10, s10, s48
s_addc_u32 s11, s11, 0
v_lshlrev_b32 v11, 16, v8
v_add_u32 v11, v11, v9
v_and_b32 v16, 7, v0
v_lshlrev_b32 v16, 5, v16
v_lshrrev_b32 v4, 4, v0
v_lshl_add_u32 v16, v4, 3, v16
s_mul_i32 s40, s34, 256
v_add_u32 v16, s40, v16
v_mov_b32 v28, 0
v_mov_b32 v29, 0
v_mov_b32 v30, 0
v_mov_b32 v31, 0
v_mov_b32 v32, 0
v_mov_b32 v33, 0
v_mov_b32 v34, 0
v_mov_b32 v35, 0
s_waitcnt lgkmcnt(0)
s_barrier
s_add_u32 s35, s35, 1
s_and_b32 s36, s35, 0xff
s_bfe_u32 s37, s35, 0x80008
s_bfe_u32 s38, s35, 0x80010
s_lshr_b32 s39, s35, 24
G0D:
s_waitcnt vmcnt(4)
v_and_b32 v27, 0xffff0000, v25
v_lshlrev_b32 v26, 16, v25
v_and_b32 v25, 0xffff0000, v24
v_lshlrev_b32 v24, 16, v24
v_mul_f32 v4, 0xbfb8aa3b, v24
v_exp_f32 v4, v4
s_nop 0
v_add_f32 v4, 1.0, v4
v_rcp_f32 v4, v4
s_nop 0
v_mul_f32 v24, v24, v4
v_cvt_pk_bf16_f32 v24, v24, 0
v_mul_f32 v4, 0xbfb8aa3b, v25
v_exp_f32 v4, v4
s_nop 0
v_add_f32 v4, 1.0, v4
v_rcp_f32 v4, v4
s_nop 0
v_mul_f32 v25, v25, v4
v_cvt_pk_bf16_f32 v25, v25, 0
v_mul_f32 v4, 0xbfb8aa3b, v26
v_exp_f32 v4, v4
s_nop 0
v_add_f32 v4, 1.0, v4
v_rcp_f32 v4, v4
s_nop 0
v_mul_f32 v26, v26, v4
v_cvt_pk_bf16_f32 v26, v26, 0
v_mul_f32 v4, 0xbfb8aa3b, v27
v_exp_f32 v4, v4
s_nop 0
v_add_f32 v4, 1.0, v4
v_rcp_f32 v4, v4
s_nop 0
v_mul_f32 v27, v27, v4
v_cvt_pk_bf16_f32 v27, v27, 0
s_waitcnt vmcnt(3)
global_load_dwordx4 v[64:67], v11, s[10:11] nt
s_add_u32 s10, s10, 8192
s_addc_u32 s11, s11, 0
v_lshlrev_b32 v6, 16, v24
v_dot2c_f32_bf16 v28, v48, v24
v_dot2c_f32_bf16 v30, v49, v24
v_dot2c_f32_bf16 v32, v50, v24
v_dot2c_f32_bf16 v34, v51, v24
v_dot2c_f32_bf16 v29, v48, v6
v_dot2c_f32_bf16 v31, v49, v6
v_dot2c_f32_bf16 v33, v50, v6
v_dot2c_f32_bf16 v35, v51, v6
s_waitcnt vmcnt(3)
global_load_dwordx4 v[68:71], v11, s[10:11] nt
s_add_u32 s10, s10, 8192
s_addc_u32 s11, s11, 0
v_lshlrev_b32 v6, 16, v25
v_dot2c_f32_bf16 v28, v52, v25
v_dot2c_f32_bf16 v30, v53, v25
v_dot2c_f32_bf16 v32, v54, v25
v_dot2c_f32_bf16 v34, v55, v25
v_dot2c_f32_bf16 v29, v52, v6
v_dot2c_f32_bf16 v31, v53, v6
v_dot2c_f32_bf16 v33, v54, v6
v_dot2c_f32_bf16 v35, v55, v6
s_waitcnt vmcnt(3)
global_load_dwordx4 v[72:75], v11, s[10:11] nt
s_add_u32 s10, s10, 8192
s_addc_u32 s11, s11, 0
v_lshlrev_b32 v6, 16, v26
v_dot2c_f32_bf16 v28, v56, v26
v_dot2c_f32_bf16 v30, v57, v26
v_dot2c_f32_bf16 v32, v58, v26
v_dot2c_f32_bf16 v34, v59, v26
v_dot2c_f32_bf16 v29, v56, v6
v_dot2c_f32_bf16 v31, v57, v6
v_dot2c_f32_bf16 v33, v58, v6
v_dot2c_f32_bf16 v35, v59, v6
s_waitcnt vmcnt(3)
global_load_dwordx4 v[76:79], v11, s[10:11] nt
s_add_u32 s10, s10, 8192
s_addc_u32 s11, s11, 0
v_lshlrev_b32 v6, 16, v27
v_dot2c_f32_bf16 v28, v60, v27
v_dot2c_f32_bf16 v30, v61, v27
v_dot2c_f32_bf16 v32, v62, v27
v_dot2c_f32_bf16 v34, v63, v27
v_dot2c_f32_bf16 v29, v60, v6
v_dot2c_f32_bf16 v31, v61, v6
v_dot2c_f32_bf16 v33, v62, v6
v_dot2c_f32_bf16 v35, v63, v6
s_nop 2
v_permlane32_swap_b32 v28, v32
v_permlane32_swap_b32 v29, v33
v_permlane32_swap_b32 v30, v34
v_permlane32_swap_b32 v31, v35
v_add_f32 v28, v28, v32
v_add_f32 v29, v29, v33
v_add_f32 v30, v30, v34
v_add_f32 v31, v31, v35
s_nop 0
v_permlane16_swap_b32 v28, v30
v_permlane16_swap_b32 v29, v31
v_add_f32 v28, v28, v30
v_add_f32 v29, v29, v31
s_nop 0
v_add_f32_dpp v28, v28, v28 row_ror:8 row_mask:0xf bank_mask:0xf
v_add_f32_dpp v29, v29, v29 row_ror:8 row_mask:0xf bank_mask:0xf
ds_write_b64 v16, v[28:29] offset:12288
s_lshr_b32 s48, s2, 5
s_mul_i32 s48, s48, 8704
s_lshl_b32 s49, s44, 8
s_add_u32 s48, s48, s49
s_lshr_b32 s49, s44, 4
s_lshl_b32 s49, s49, 8
s_add_u32 s48, s48, s49
s_add_u32 s48, s48, 4096
s_add_u32 s50, s30, s48
s_addc_u32 s51, s31, 0
s_mov_b64 exec, 1
ds_add_rtn_u32 v4, v1, v2 offset:56
s_mov_b64 exec, -1
s_waitcnt lgkmcnt(0)
v_readfirstlane_b32 s40, v4
s_cmp_lg_u32 s40, 3
s_cbranch_scc1 LP1
LP1x:
s_mov_b32 exec_lo, 0xffff
s_mov_b32 exec_hi, 0x0
ds_read_b128 v[28:31], v5 offset:12288
ds_read_b128 v[32:35], v5 offset:12544
ds_read_b128 v[36:39], v5 offset:12800
ds_read_b128 v[40:43], v5 offset:13056
s_waitcnt lgkmcnt(2)
v_add_f32 v28, v28, v32
v_add_f32 v29, v29, v33
v_add_f32 v30, v30, v34
v_add_f32 v31, v31, v35
s_waitcnt lgkmcnt(0)
v_add_f32 v36, v36, v40
v_add_f32 v37, v37, v41
v_add_f32 v38, v38, v42
v_add_f32 v39, v39, v43
v_add_f32 v28, v28, v36
v_add_f32 v29, v29, v37
v_add_f32 v30, v30, v38
v_add_f32 v31, v31, v39
v_and_or_b32 v28, v28, v3, s36
v_and_or_b32 v29, v29, v3, s37
v_and_or_b32 v30, v30, v3, s38
v_and_or_b32 v31, v31, v3, s39
global_store_dwordx4 v5, v[28:31], s[50:51] sc1
s_mov_b64 exec, -1
s_mov_b64 exec, 1
ds_add_u32 v1, v2 offset:28
s_mov_b64 exec, -1
LP1:
s_waitcnt vmcnt(3)
global_load_dwordx4 v[80:83], v11, s[10:11] nt
s_add_u32 s10, s10, 8192
s_addc_u32 s11, s11, 0
s_waitcnt vmcnt(3)
global_load_dwordx4 v[84:87], v11, s[10:11] nt
s_add_u32 s10, s10, 8192
s_addc_u32 s11, s11, 0
s_waitcnt vmcnt(3)
global_load_dwordx4 v[88:91], v11, s[10:11] nt
s_add_u32 s10, s10, 8192
s_addc_u32 s11, s11, 0
s_waitcnt vmcnt(3)
global_load_dwordx4 v[92:95], v11, s[10:11] nt
s_waitcnt vmcnt(3)
s_waitcnt vmcnt(1)
s_mov_b64 exec, 1
ds_add_u32 v7, v2 offset:128
s_mov_b64 exec, -1
v_mov_b32 v28, 0
v_mov_b32 v29, 0
v_mov_b32 v30, 0
v_mov_b32 v31, 0
v_mov_b32 v32, 0
v_mov_b32 v33, 0
v_mov_b32 v34, 0
v_mov_b32 v35, 0
s_lshl_b32 s48, s34, 8
v_lshlrev_b32 v10, 5, v8
v_add_u32 v10, s48, v10
s_lshl_b32 s48, s47, 14
s_lshl_b32 s49, s46, 8
s_add_u32 s48, s48, s49
s_add_u32 s48, s48, 143360
s_add_u32 s50, s30, s48
s_addc_u32 s51, s31, 0
SP2:
ds_read_b32 v4, v1 offset:0
s_waitcnt lgkmcnt(0)
v_readfirstlane_b32 s40, v4
s_sub_u32 s43, s43, 1
s_cbranch_scc1 EXIT
s_cmp_ge_u32 s40, 4
s_cbranch_scc1 SD3
s_branch SP2
SD3:
ds_read_b128 v[20:23], v10 offset:1024
ds_read_b128 v[24:27], v10 offset:1040
s_waitcnt vmcnt(0) lgkmcnt(0)
v_lshlrev_b32 v6, 16, v20
v_dot2c_f32_bf16 v28, v64, v20
v_dot2c_f32_bf16 v30, v65, v20
v_dot2c_f32_bf16 v32, v66, v20
v_dot2c_f32_bf16 v34, v67, v20
v_dot2c_f32_bf16 v29, v64, v6
v_dot2c_f32_bf16 v31, v65, v6
v_dot2c_f32_bf16 v33, v66, v6
v_dot2c_f32_bf16 v35, v67, v6
v_lshlrev_b32 v6, 16, v21
v_dot2c_f32_bf16 v28, v68, v21
v_dot2c_f32_bf16 v30, v69, v21
v_dot2c_f32_bf16 v32, v70, v21
v_dot2c_f32_bf16 v34, v71, v21
v_dot2c_f32_bf16 v29, v68, v6
v_dot2c_f32_bf16 v31, v69, v6
v_dot2c_f32_bf16 v33, v70, v6
v_dot2c_f32_bf16 v35, v71, v6
v_lshlrev_b32 v6, 16, v22
v_dot2c_f32_bf16 v28, v72, v22
v_dot2c_f32_bf16 v30, v73, v22
v_dot2c_f32_bf16 v32, v74, v22
v_dot2c_f32_bf16 v34, v75, v22
v_dot2c_f32_bf16 v29, v72, v6
v_dot2c_f32_bf16 v31, v73, v6
v_dot2c_f32_bf16 v33, v74, v6
v_dot2c_f32_bf16 v35, v75, v6
v_lshlrev_b32 v6, 16, v23
v_dot2c_f32_bf16 v28, v76, v23
v_dot2c_f32_bf16 v30, v77, v23
v_dot2c_f32_bf16 v32, v78, v23
v_dot2c_f32_bf16 v34, v79, v23
v_dot2c_f32_bf16 v29, v76, v6
v_dot2c_f32_bf16 v31, v77, v6
v_dot2c_f32_bf16 v33, v78, v6
v_dot2c_f32_bf16 v35, v79, v6
v_lshlrev_b32 v6, 16, v24
v_dot2c_f32_bf16 v28, v80, v24
v_dot2c_f32_bf16 v30, v81, v24
v_dot2c_f32_bf16 v32, v82, v24
v_dot2c_f32_bf16 v34, v83, v24
v_dot2c_f32_bf16 v29, v80, v6
v_dot2c_f32_bf16 v31, v81, v6
v_dot2c_f32_bf16 v33, v82, v6
v_dot2c_f32_bf16 v35, v83, v6
v_lshlrev_b32 v6, 16, v25
v_dot2c_f32_bf16 v28, v84, v25
v_dot2c_f32_bf16 v30, v85, v25
v_dot2c_f32_bf16 v32, v86, v25
v_dot2c_f32_bf16 v34, v87, v25
v_dot2c_f32_bf16 v29, v84, v6
v_dot2c_f32_bf16 v31, v85, v6
v_dot2c_f32_bf16 v33, v86, v6
v_dot2c_f32_bf16 v35, v87, v6
v_lshlrev_b32 v6, 16, v26
v_dot2c_f32_bf16 v28, v88, v26
v_dot2c_f32_bf16 v30, v89, v26
v_dot2c_f32_bf16 v32, v90, v26
v_dot2c_f32_bf16 v34, v91, v26
v_dot2c_f32_bf16 v29, v88, v6
v_dot2c_f32_bf16 v31, v89, v6
v_dot2c_f32_bf16 v33, v90, v6
v_dot2c_f32_bf16 v35, v91, v6
v_lshlrev_b32 v6, 16, v27
v_dot2c_f32_bf16 v28, v92, v27
v_dot2c_f32_bf16 v30, v93, v27
v_dot2c_f32_bf16 v32, v94, v27
v_dot2c_f32_bf16 v34, v95, v27
v_dot2c_f32_bf16 v29, v92, v6
v_dot2c_f32_bf16 v31, v93, v6
v_dot2c_f32_bf16 v33, v94, v6
v_dot2c_f32_bf16 v35, v95, v6
s_nop 2
v_permlane32_swap_b32 v28, v32
v_permlane32_swap_b32 v29, v33
v_permlane32_swap_b32 v30, v34
v_permlane32_swap_b32 v31, v35
v_add_f32 v28, v28, v32
v_add_f32 v29, v29, v33
v_add_f32 v30, v30, v34
v_add_f32 v31, v31, v35
s_nop 0
v_permlane16_swap_b32 v28, v30
v_permlane16_swap_b32 v29, v31
v_add_f32 v28, v28, v30
v_add_f32 v29, v29, v31
s_nop 0
v_add_f32_dpp v28, v28, v28 row_ror:8 row_mask:0xf bank_mask:0xf
v_add_f32_dpp v29, v29, v29 row_ror:8 row_mask:0xf bank_mask:0xf
ds_write_b64 v16, v[28:29] offset:13312
s_mov_b64 exec, 1
ds_add_rtn_u32 v4, v1, v2 offset:60
s_mov_b64 exec, -1
s_waitcnt lgkmcnt(0)
v_readfirstlane_b32 s40, v4
s_cmp_lg_u32 s40, 3
s_cbranch_scc1 LP4
LP4x:
s_mov_b32 exec_lo, 0xffff
s_mov_b32 exec_hi, 0x0
ds_read_b128 v[28:31], v5 offset:13312
ds_read_b128 v[32:35], v5 offset:13568
ds_read_b128 v[36:39], v5 offset:13824
ds_read_b128 v[40:43], v5 offset:14080
s_waitcnt lgkmcnt(2)
v_add_f32 v28, v28, v32
v_add_f32 v29, v29, v33
v_add_f32 v30, v30, v34
v_add_f32 v31, v31, v35
s_waitcnt lgkmcnt(0)
v_add_f32 v36, v36, v40
v_add_f32 v37, v37, v41
v_add_f32 v38, v38, v42
v_add_f32 v39, v39, v43
v_add_f32 v28, v28, v36
v_add_f32 v29, v29, v37
v_add_f32 v30, v30, v38
v_add_f32 v31, v31, v39
v_and_or_b32 v28, v28, v3, s36
v_and_or_b32 v29, v29, v3, s37
v_and_or_b32 v30, v30, v3, s38
v_and_or_b32 v31, v31, v3, s39
global_store_dwordx4 v5, v[28:31], s[50:51] sc1
s_mov_b64 exec, -1
s_mov_b64 exec, 1
ds_add_u32 v1, v2 offset:32
s_mov_b64 exec, -1
LP4:
v_and_b32 v12, 15, v0
v_lshrrev_b32 v13, 4, v0
s_bfe_u32 s54, s2, 0x30003
s_lshr_b32 s55, s2, 6
s_lshl_b32 s55, s55, 3
s_and_b32 s48, s2, 7
s_or_b32 s55, s55, s48
s_lshl_b32 s48, s55, 7
s_lshl_b32 s49, s34, 5
s_add_u32 s48, s48, s49
s_lshl_b32 s48, s48, 11
s_lshl_b32 s49, s54, 8
s_add_u32 s48, s48, s49
s_add_u32 s12, s12, s48
s_addc_u32 s13, s13, 0
v_lshlrev_b32 v11, 14, v13
v_lshl_add_u32 v11, v12, 4, v11
s_mul_i32 s48, s55, 4352
s_lshl_b32 s49, s54, 9
s_add_u32 s48, s48, s49
s_add_u32 s48, s48, 262144
s_add_u32 s52, s30, s48
s_addc_u32 s53, s31, 0
SP5:
ds_read_b32 v4, v7 offset:176
s_waitcnt lgkmcnt(0)
v_readfirstlane_b32 s40, v4
s_sub_u32 s43, s43, 1
s_cbranch_scc1 EXIT
s_cmp_ge_u32 s40, 1
s_cbranch_scc1 SD6
s_sleep 1
s_branch SP5
SD6:
global_load_dwordx4 v[96:99], v11, s[12:13] nt
s_add_u32 s12, s12, 2048
s_addc_u32 s13, s13, 0
s_waitcnt vmcnt(3)
global_load_dwordx4 v[100:103], v11, s[12:13] nt
s_add_u32 s12, s12, 2048
s_addc_u32 s13, s13, 0
s_waitcnt vmcnt(3)
global_load_dwordx4 v[104:107], v11, s[12:13] nt
s_add_u32 s12, s12, 2048
s_addc_u32 s13, s13, 0
s_waitcnt vmcnt(3)
global_load_dwordx4 v[108:111], v11, s[12:13] nt
s_add_u32 s12, s12, 2048
s_addc_u32 s13, s13, 0
s_waitcnt vmcnt(3)
global_load_dwordx4 v[112:115], v11, s[12:13] nt
s_add_u32 s12, s12, 2048
s_addc_u32 s13, s13, 0
s_waitcnt vmcnt(3)
global_load_dwordx4 v[116:119], v11, s[12:13] nt
s_add_u32 s12, s12, 2048
s_addc_u32 s13, s13, 0
s_waitcnt vmcnt(3)
global_load_dwordx4 v[120:123], v11, s[12:13] nt
s_add_u32 s12, s12, 2048
s_addc_u32 s13, s13, 0
s_waitcnt vmcnt(3)
global_load_dwordx4 v[124:127], v11, s[12:13] nt
s_waitcnt vmcnt(3)
s_waitcnt vmcnt(1)
s_mov_b64 exec, 1
ds_add_u32 v7, v2 offset:192
s_mov_b64 exec, -1
v_and_b32 v17, 15, v0
v_lshlrev_b32 v17, 5, v17
v_lshrrev_b32 v4, 4, v0
v_lshl_add_u32 v17, v4, 3, v17
s_mul_i32 s40, s34, 512
v_add_u32 v17, s40, v17
s_lshl_b32 s48, s34, 7
v_lshlrev_b32 v18, 5, v13
v_add_u32 v18, s48, v18
v_mov_b32 v28, 0
v_mov_b32 v29, 0
v_mov_b32 v30, 0
v_mov_b32 v31, 0
v_mov_b32 v32, 0
v_mov_b32 v33, 0
v_mov_b32 v34, 0
v_mov_b32 v35, 0
SP7:
ds_read_b32 v4, v1 offset:8
s_waitcnt lgkmcnt(0)
v_readfirstlane_b32 s40, v4
s_sub_u32 s43, s43, 1
s_cbranch_scc1 EXIT
s_cmp_ge_u32 s40, 4
s_cbranch_scc1 SD8
s_branch SP7
SD8:
ds_read_b128 v[44:47], v18 offset:6144
ds_read_b128 v[48:51], v18 offset:6160
s_waitcnt vmcnt(0) lgkmcnt(0)
v_lshlrev_b32 v6, 16, v44
v_dot2c_f32_bf16 v28, v96, v44
v_dot2c_f32_bf16 v30, v97, v44
v_dot2c_f32_bf16 v32, v98, v44
v_dot2c_f32_bf16 v34, v99, v44
v_dot2c_f32_bf16 v29, v96, v6
v_dot2c_f32_bf16 v31, v97, v6
v_dot2c_f32_bf16 v33, v98, v6
v_dot2c_f32_bf16 v35, v99, v6
v_lshlrev_b32 v6, 16, v45
v_dot2c_f32_bf16 v28, v100, v45
v_dot2c_f32_bf16 v30, v101, v45
v_dot2c_f32_bf16 v32, v102, v45
v_dot2c_f32_bf16 v34, v103, v45
v_dot2c_f32_bf16 v29, v100, v6
v_dot2c_f32_bf16 v31, v101, v6
v_dot2c_f32_bf16 v33, v102, v6
v_dot2c_f32_bf16 v35, v103, v6
v_lshlrev_b32 v6, 16, v46
v_dot2c_f32_bf16 v28, v104, v46
v_dot2c_f32_bf16 v30, v105, v46
v_dot2c_f32_bf16 v32, v106, v46
v_dot2c_f32_bf16 v34, v107, v46
v_dot2c_f32_bf16 v29, v104, v6
v_dot2c_f32_bf16 v31, v105, v6
v_dot2c_f32_bf16 v33, v106, v6
v_dot2c_f32_bf16 v35, v107, v6
v_lshlrev_b32 v6, 16, v47
v_dot2c_f32_bf16 v28, v108, v47
v_dot2c_f32_bf16 v30, v109, v47
v_dot2c_f32_bf16 v32, v110, v47
v_dot2c_f32_bf16 v34, v111, v47
v_dot2c_f32_bf16 v29, v108, v6
v_dot2c_f32_bf16 v31, v109, v6
v_dot2c_f32_bf16 v33, v110, v6
v_dot2c_f32_bf16 v35, v111, v6
v_lshlrev_b32 v6, 16, v48
v_dot2c_f32_bf16 v28, v112, v48
v_dot2c_f32_bf16 v30, v113, v48
v_dot2c_f32_bf16 v32, v114, v48
v_dot2c_f32_bf16 v34, v115, v48
v_dot2c_f32_bf16 v29, v112, v6
v_dot2c_f32_bf16 v31, v113, v6
v_dot2c_f32_bf16 v33, v114, v6
v_dot2c_f32_bf16 v35, v115, v6
v_lshlrev_b32 v6, 16, v49
v_dot2c_f32_bf16 v28, v116, v49
v_dot2c_f32_bf16 v30, v117, v49
v_dot2c_f32_bf16 v32, v118, v49
v_dot2c_f32_bf16 v34, v119, v49
v_dot2c_f32_bf16 v29, v116, v6
v_dot2c_f32_bf16 v31, v117, v6
v_dot2c_f32_bf16 v33, v118, v6
v_dot2c_f32_bf16 v35, v119, v6
v_lshlrev_b32 v6, 16, v50
v_dot2c_f32_bf16 v28, v120, v50
v_dot2c_f32_bf16 v30, v121, v50
v_dot2c_f32_bf16 v32, v122, v50
v_dot2c_f32_bf16 v34, v123, v50
v_dot2c_f32_bf16 v29, v120, v6
v_dot2c_f32_bf16 v31, v121, v6
v_dot2c_f32_bf16 v33, v122, v6
v_dot2c_f32_bf16 v35, v123, v6
v_lshlrev_b32 v6, 16, v51
v_dot2c_f32_bf16 v28, v124, v51
v_dot2c_f32_bf16 v30, v125, v51
v_dot2c_f32_bf16 v32, v126, v51
v_dot2c_f32_bf16 v34, v127, v51
v_dot2c_f32_bf16 v29, v124, v6
v_dot2c_f32_bf16 v31, v125, v6
v_dot2c_f32_bf16 v33, v126, v6
v_dot2c_f32_bf16 v35, v127, v6
s_nop 2
v_permlane32_swap_b32 v28, v32
v_permlane32_swap_b32 v29, v33
v_permlane32_swap_b32 v30, v34
v_permlane32_swap_b32 v31, v35
v_add_f32 v28, v28, v32
v_add_f32 v29, v29, v33
v_add_f32 v30, v30, v34
v_add_f32 v31, v31, v35
s_nop 0
v_permlane16_swap_b32 v28, v30
v_permlane16_swap_b32 v29, v31
v_add_f32 v28, v28, v30
v_add_f32 v29, v29, v31
ds_write_b64 v17, v[28:29] offset:16384
s_mov_b64 exec, 1
ds_add_rtn_u32 v4, v1, v2 offset:68
s_mov_b64 exec, -1
s_waitcnt lgkmcnt(0)
v_readfirstlane_b32 s40, v4
s_cmp_lg_u32 s40, 3
s_cbranch_scc1 LP9
LP9x:
s_mov_b32 exec_lo, 0xffffffff
s_mov_b32 exec_hi, 0x0
ds_read_b128 v[44:47], v5 offset:16384
ds_read_b128 v[48:51], v5 offset:16896
ds_read_b128 v[52:55], v5 offset:17408
ds_read_b128 v[56:59], v5 offset:17920
s_waitcnt lgkmcnt(2)
v_add_f32 v44, v44, v48
v_add_f32 v45, v45, v49
v_add_f32 v46, v46, v50
v_add_f32 v47, v47, v51
s_waitcnt lgkmcnt(0)
v_add_f32 v52, v52, v56
v_add_f32 v53, v53, v57
v_add_f32 v54, v54, v58
v_add_f32 v55, v55, v59
v_add_f32 v44, v44, v52
v_add_f32 v45, v45, v53
v_add_f32 v46, v46, v54
v_add_f32 v47, v47, v55
v_and_or_b32 v44, v44, v3, s36
v_and_or_b32 v45, v45, v3, s37
v_and_or_b32 v46, v46, v3, s38
v_and_or_b32 v47, v47, v3, s39
global_store_dwordx4 v5, v[44:47], s[52:53] sc1
s_mov_b64 exec, -1
s_mov_b64 exec, 1
ds_add_u32 v1, v2 offset:40
s_mov_b64 exec, -1
LP9:
s_bfe_u32 s44, s2, 0x40003
s_lshr_b32 s45, s2, 7
s_lshl_b32 s45, s45, 3
s_and_b32 s46, s2, 7
s_or_b32 s45, s45, s46
s_mul_i32 s46, s45, 224
s_mul_i32 s47, s34, 56
s_add_u32 s46, s46, s47
s_lshl_b32 s46, s46, 11
s_lshl_b32 s48, s44, 7
s_add_u32 s46, s46, s48
s_add_u32 s20, s20, s46
s_addc_u32 s21, s21, 0
v_and_b32 v9, 7, v0
v_lshlrev_b32 v9, 4, v9
v_mul_u32_u24 v10, 14336, v8
v_add_u32 v10, v10, v9
v_mul_u32_u24 v11, 28, v8
s_lshl_b32 s47, s47, 2
v_add_u32 v11, s47, v11
s_mul_i32 s48, s45, 4352
s_lshl_b32 s49, s44, 8
s_add_u32 s48, s48, s49
s_add_u32 s48, s48, 806912
s_add_u32 s50, s30, s48
s_addc_u32 s51, s31, 0
v_mov_b32 v28, 0
v_mov_b32 v29, 0
v_mov_b32 v30, 0
v_mov_b32 v31, 0
v_mov_b32 v32, 0
v_mov_b32 v33, 0
v_mov_b32 v34, 0
v_mov_b32 v35, 0
SP10:
ds_read_b32 v4, v7 offset:160
s_waitcnt lgkmcnt(0)
v_readfirstlane_b32 s40, v4
s_sub_u32 s43, s43, 1
s_cbranch_scc1 EXIT
s_cmp_ge_u32 s40, 1
s_cbranch_scc1 SD11
s_sleep 1
s_branch SP10
SD11:
global_load_dwordx4 v[64:67], v10, s[20:21] nt
s_add_u32 s20, s20, 2048
s_addc_u32 s21, s21, 0
s_waitcnt vmcnt(3)
global_load_dwordx4 v[68:71], v10, s[20:21] nt
s_add_u32 s20, s20, 2048
s_addc_u32 s21, s21, 0
s_waitcnt vmcnt(3)
global_load_dwordx4 v[72:75], v10, s[20:21] nt
s_add_u32 s20, s20, 2048
s_addc_u32 s21, s21, 0
s_waitcnt vmcnt(3)
global_load_dwordx4 v[76:79], v10, s[20:21] nt
s_add_u32 s20, s20, 2048
s_addc_u32 s21, s21, 0
s_waitcnt vmcnt(3)
global_load_dwordx4 v[80:83], v10, s[20:21] nt
s_add_u32 s20, s20, 2048
s_addc_u32 s21, s21, 0
s_waitcnt vmcnt(3)
global_load_dwordx4 v[84:87], v10, s[20:21] nt
s_add_u32 s20, s20, 2048
s_addc_u32 s21, s21, 0
s_waitcnt vmcnt(3)
global_load_dwordx4 v[88:91], v10, s[20:21] nt
s_waitcnt vmcnt(3)
SP12:
ds_read_b32 v4, v1 offset:16
s_waitcnt lgkmcnt(0)
v_readfirstlane_b32 s40, v4
s_sub_u32 s43, s43, 1
s_cbranch_scc1 EXIT
s_cmp_ge_u32 s40, 4
s_cbranch_scc1 SD13
s_branch SP12
SD13:
ds_read_b32 v20, v11 offset:10240
ds_read_b32 v21, v11 offset:10244
ds_read_b32 v22, v11 offset:10248
ds_read_b32 v23, v11 offset:10252
ds_read_b32 v24, v11 offset:10256
ds_read_b32 v25, v11 offset:10260
ds_read_b32 v26, v11 offset:10264
s_waitcnt vmcnt(0) lgkmcnt(0)
v_lshlrev_b32 v6, 16, v20
v_dot2c_f32_bf16 v28, v64, v20
v_dot2c_f32_bf16 v30, v65, v20
v_dot2c_f32_bf16 v32, v66, v20
v_dot2c_f32_bf16 v34, v67, v20
v_dot2c_f32_bf16 v29, v64, v6
v_dot2c_f32_bf16 v31, v65, v6
v_dot2c_f32_bf16 v33, v66, v6
v_dot2c_f32_bf16 v35, v67, v6
v_lshlrev_b32 v6, 16, v21
v_dot2c_f32_bf16 v28, v68, v21
v_dot2c_f32_bf16 v30, v69, v21
v_dot2c_f32_bf16 v32, v70, v21
v_dot2c_f32_bf16 v34, v71, v21
v_dot2c_f32_bf16 v29, v68, v6
v_dot2c_f32_bf16 v31, v69, v6
v_dot2c_f32_bf16 v33, v70, v6
v_dot2c_f32_bf16 v35, v71, v6
v_lshlrev_b32 v6, 16, v22
v_dot2c_f32_bf16 v28, v72, v22
v_dot2c_f32_bf16 v30, v73, v22
v_dot2c_f32_bf16 v32, v74, v22
v_dot2c_f32_bf16 v34, v75, v22
v_dot2c_f32_bf16 v29, v72, v6
v_dot2c_f32_bf16 v31, v73, v6
v_dot2c_f32_bf16 v33, v74, v6
v_dot2c_f32_bf16 v35, v75, v6
v_lshlrev_b32 v6, 16, v23
v_dot2c_f32_bf16 v28, v76, v23
v_dot2c_f32_bf16 v30, v77, v23
v_dot2c_f32_bf16 v32, v78, v23
v_dot2c_f32_bf16 v34, v79, v23
v_dot2c_f32_bf16 v29, v76, v6
v_dot2c_f32_bf16 v31, v77, v6
v_dot2c_f32_bf16 v33, v78, v6
v_dot2c_f32_bf16 v35, v79, v6
v_lshlrev_b32 v6, 16, v24
v_dot2c_f32_bf16 v28, v80, v24
v_dot2c_f32_bf16 v30, v81, v24
v_dot2c_f32_bf16 v32, v82, v24
v_dot2c_f32_bf16 v34, v83, v24
v_dot2c_f32_bf16 v29, v80, v6
v_dot2c_f32_bf16 v31, v81, v6
v_dot2c_f32_bf16 v33, v82, v6
v_dot2c_f32_bf16 v35, v83, v6
v_lshlrev_b32 v6, 16, v25
v_dot2c_f32_bf16 v28, v84, v25
v_dot2c_f32_bf16 v30, v85, v25
v_dot2c_f32_bf16 v32, v86, v25
v_dot2c_f32_bf16 v34, v87, v25
v_dot2c_f32_bf16 v29, v84, v6
v_dot2c_f32_bf16 v31, v85, v6
v_dot2c_f32_bf16 v33, v86, v6
v_dot2c_f32_bf16 v35, v87, v6
v_lshlrev_b32 v6, 16, v26
v_dot2c_f32_bf16 v28, v88, v26
v_dot2c_f32_bf16 v30, v89, v26
v_dot2c_f32_bf16 v32, v90, v26
v_dot2c_f32_bf16 v34, v91, v26
v_dot2c_f32_bf16 v29, v88, v6
v_dot2c_f32_bf16 v31, v89, v6
v_dot2c_f32_bf16 v33, v90, v6
v_dot2c_f32_bf16 v35, v91, v6
s_nop 2
v_permlane32_swap_b32 v28, v32
v_permlane32_swap_b32 v29, v33
v_permlane32_swap_b32 v30, v34
v_permlane32_swap_b32 v31, v35
v_add_f32 v28, v28, v32
v_add_f32 v29, v29, v33
v_add_f32 v30, v30, v34
v_add_f32 v31, v31, v35
s_nop 0
v_permlane16_swap_b32 v28, v30
v_permlane16_swap_b32 v29, v31
v_add_f32 v28, v28, v30
v_add_f32 v29, v29, v31
s_nop 0
v_add_f32_dpp v28, v28, v28 row_ror:8 row_mask:0xf bank_mask:0xf
v_add_f32_dpp v29, v29, v29 row_ror:8 row_mask:0xf bank_mask:0xf
ds_write_b64 v16, v[28:29] offset:14336
s_mov_b64 exec, 1
ds_add_rtn_u32 v4, v1, v2 offset:80
s_mov_b64 exec, -1
s_waitcnt lgkmcnt(0)
v_readfirstlane_b32 s40, v4
s_cmp_lg_u32 s40, 3
s_cbranch_scc1 LP14
LP14x:
s_mov_b32 exec_lo, 0xffff
s_mov_b32 exec_hi, 0x0
ds_read_b128 v[28:31], v5 offset:14336
ds_read_b128 v[32:35], v5 offset:14592
ds_read_b128 v[36:39], v5 offset:14848
ds_read_b128 v[40:43], v5 offset:15104
s_waitcnt lgkmcnt(2)
v_add_f32 v28, v28, v32
v_add_f32 v29, v29, v33
v_add_f32 v30, v30, v34
v_add_f32 v31, v31, v35
s_waitcnt lgkmcnt(0)
v_add_f32 v36, v36, v40
v_add_f32 v37, v37, v41
v_add_f32 v38, v38, v42
v_add_f32 v39, v39, v43
v_add_f32 v28, v28, v36
v_add_f32 v29, v29, v37
v_add_f32 v30, v30, v38
v_add_f32 v31, v31, v39
v_and_or_b32 v28, v28, v3, s36
v_and_or_b32 v29, v29, v3, s37
v_and_or_b32 v30, v30, v3, s38
v_and_or_b32 v31, v31, v3, s39
global_store_dwordx4 v5, v[28:31], s[50:51] sc1
s_mov_b64 exec, -1
s_mov_b64 exec, 1
ds_add_u32 v1, v2 offset:52
s_mov_b64 exec, -1
LP14:
s_endpgm
G1:
s_lshr_b32 s46, s2, 2
s_and_b32 s47, s2, 3
s_lshl_b32 s48, s47, 24
s_lshl_b32 s49, s46, 14
s_add_u32 s48, s48, s49
s_lshl_b32 s49, s34, 12
s_add_u32 s48, s48, s49
s_add_u32 s48, s48, 15728640
s_add_u32 s6, s6, s48
s_addc_u32 s7, s7, 0
s_add_u32 s8, s8, s48
s_addc_u32 s9, s9, 0
v_and_b32 v12, 15, v0
v_lshrrev_b32 v13, 4, v0
v_lshlrev_b32 v14, 8, v12
v_lshl_add_u32 v14, v13, 4, v14
v_lshlrev_b32 v15, 10, v13
v_lshl_add_u32 v15, v12, 4, v15
s_waitcnt lgkmcnt(0)
s_barrier
s_add_u32 s35, s35, 1
s_and_b32 s36, s35, 0xff
s_bfe_u32 s37, s35, 0x80008
s_bfe_u32 s38, s35, 0x80010
s_lshr_b32 s39, s35, 24
G1D:
SP15:
ds_read_b32 v4, v7 offset:128
s_waitcnt lgkmcnt(0)
v_readfirstlane_b32 s40, v4
s_sub_u32 s43, s43, 1
s_cbranch_scc1 EXIT
s_cmp_ge_u32 s40, 1
s_cbranch_scc1 SD16
s_sleep 1
s_branch SP15
SD16:
global_load_dwordx4 v[96:99], v14, s[6:7] offset:0 nt
s_waitcnt vmcnt(3)
global_load_dwordx4 v[100:103], v14, s[6:7] offset:64 nt
s_waitcnt vmcnt(3)
global_load_dwordx4 v[104:107], v14, s[6:7] offset:128 nt
s_waitcnt vmcnt(3)
global_load_dwordx4 v[108:111], v14, s[6:7] offset:192 nt
s_waitcnt vmcnt(3)
global_load_dwordx4 v[112:115], v15, s[8:9] offset:0 nt
s_waitcnt vmcnt(3)
global_load_dwordx4 v[116:119], v15, s[8:9] offset:256 nt
s_waitcnt vmcnt(3)
global_load_dwordx4 v[120:123], v15, s[8:9] offset:512 nt
s_waitcnt vmcnt(3)
global_load_dwordx4 v[124:127], v15, s[8:9] offset:768 nt
s_waitcnt vmcnt(1)
s_mov_b64 exec, 1
ds_add_u32 v7, v2 offset:144
s_mov_b64 exec, -1
s_waitcnt vmcnt(0)
s_mov_b32 s48, 0x05040100
s_mov_b32 s49, 0x07060302
v_perm_b32 v64, v116, v112, s48
v_perm_b32 v65, v124, v120, s48
v_perm_b32 v66, v116, v112, s49
v_perm_b32 v67, v124, v120, s49
v_perm_b32 v68, v117, v113, s48
v_perm_b32 v69, v125, v121, s48
v_perm_b32 v70, v117, v113, s49
v_perm_b32 v71, v125, v121, s49
v_perm_b32 v72, v118, v114, s48
v_perm_b32 v73, v126, v122, s48
v_perm_b32 v74, v118, v114, s49
v_perm_b32 v75, v126, v122, s49
v_perm_b32 v76, v119, v115, s48
v_perm_b32 v77, v127, v123, s48
v_perm_b32 v78, v119, v115, s49
v_perm_b32 v79, v127, v123, s49
v_and_b32 v10, 7, v0
v_mul_u32_u24 v10, 272, v10
v_lshl_add_u32 v10, v13, 4, v10
v_mov_b32 v28, 0
v_mov_b32 v29, 0
v_mov_b32 v30, 0
v_mov_b32 v31, 0
s_lshl_b32 s48, s47, 3
s_lshl_b32 s49, s34, 1
s_add_u32 s48, s48, s49
s_lshl_b32 s48, s48, 6
s_add_u32 s48, s48, s46
s_mul_i32 s49, s48, 640
s_add_u32 s49, s49, 2097152
s_add_u32 s50, s30, s49
s_addc_u32 s51, s31, 0
v_lshrrev_b32 v17, 5, v0
v_and_b32 v18, 31, v0
v_lshlrev_b32 v18, 4, v18
v_mul_u32_u24 v19, 40960, v17
v_add_u32 v19, v19, v18
s_mul_i32 s48, s34, 4224
v_and_b32 v21, 7, v0
v_mul_u32_u24 v21, 528, v21
v_lshl_add_u32 v21, v13, 7, v21
v_add_u32 v21, s48, v21
s_mul_i32 s48, s34, 1056
v_mul_u32_u24 v22, 528, v17
v_add_u32 v22, v22, v18
v_add_u32 v22, s48, v22
s_lshl_b32 s48, s34, 6
v_and_b32 v23, 7, v0
v_lshlrev_b32 v23, 3, v23
v_add_u32 v23, s48, v23
s_lshl_b32 s48, s34, 4
v_lshlrev_b32 v9, 3, v17
v_add_u32 v9, s48, v9
SP17:
ds_read_b32 v4, v1 offset:4
s_waitcnt lgkmcnt(0)
v_readfirstlane_b32 s40, v4
s_sub_u32 s43, s43, 1
s_cbranch_scc1 EXIT
s_cmp_ge_u32 s40, 4
s_cbranch_scc1 SD18
s_branch SP17
SD18:
ds_read_b128 v[32:35], v10 offset:2048
ds_read_b128 v[36:39], v10 offset:2112
ds_read_b128 v[40:43], v10 offset:2176
ds_read_b128 v[44:47], v10 offset:2240
s_waitcnt lgkmcnt(3)
v_mfma_f32_16x16x32_bf16 v[28:31], v[96:99], v[32:35], v[28:31]
s_waitcnt lgkmcnt(2)
v_mfma_f32_16x16x32_bf16 v[28:31], v[100:103], v[36:39], v[28:31]
s_waitcnt lgkmcnt(1)
v_mfma_f32_16x16x32_bf16 v[28:31], v[104:107], v[40:43], v[28:31]
s_waitcnt lgkmcnt(0)
v_mfma_f32_16x16x32_bf16 v[28:31], v[108:111], v[44:47], v[28:31]
s_nop 7
v_cvt_pk_bf16_f32 v28, 0, v28
v_cvt_pk_bf16_f32 v29, 0, v29
v_cvt_pk_bf16_f32 v30, 0, v30
v_cvt_pk_bf16_f32 v31, 0, v31
v_mul_f32 v28, 0x3db504f3, v28
v_mul_f32 v29, 0x3db504f3, v29
v_mul_f32 v30, 0x3db504f3, v30
v_mul_f32 v31, 0x3db504f3, v31
v_cvt_pk_bf16_f32 v28, 0, v28
v_cvt_pk_bf16_f32 v29, 0, v29
v_cvt_pk_bf16_f32 v30, 0, v30
v_cvt_pk_bf16_f32 v31, 0, v31
v_max3_f32 v24, v28, v29, v30
v_max_f32 v24, v24, v31
v_mov_b32 v4, v24
s_nop 1
v_permlane16_swap_b32 v24, v4
v_max_f32 v24, v24, v4
v_mov_b32 v4, v24
s_nop 1
v_permlane32_swap_b32 v24, v4
v_max_f32 v24, v24, v4
v_sub_f32 v28, v28, v24
v_sub_f32 v29, v29, v24
v_sub_f32 v30, v30, v24
v_sub_f32 v31, v31, v24
v_mul_f32 v28, 0x3fb8aa3b, v28
v_mul_f32 v29, 0x3fb8aa3b, v29
v_mul_f32 v30, 0x3fb8aa3b, v30
v_mul_f32 v31, 0x3fb8aa3b, v31
v_exp_f32 v28, v28
v_exp_f32 v29, v29
v_exp_f32 v30, v30
v_exp_f32 v31, v31
s_nop 0
v_cvt_pk_bf16_f32 v26, v28, v29
v_cvt_pk_bf16_f32 v27, v30, v31
v_add_f32 v25, v28, v29
v_add_f32 v4, v30, v31
v_add_f32 v25, v25, v4
v_mfma_f32_16x16x16_bf16 v[80:83], v[64:65], v[26:27], 0
v_mfma_f32_16x16x16_bf16 v[84:87], v[66:67], v[26:27], 0
v_mfma_f32_16x16x16_bf16 v[88:91], v[68:69], v[26:27], 0
v_mfma_f32_16x16x16_bf16 v[92:95], v[70:71], v[26:27], 0
v_mfma_f32_16x16x16_bf16 v[96:99], v[72:73], v[26:27], 0
v_mfma_f32_16x16x16_bf16 v[100:103], v[74:75], v[26:27], 0
v_mfma_f32_16x16x16_bf16 v[104:107], v[76:77], v[26:27], 0
v_mfma_f32_16x16x16_bf16 v[108:111], v[78:79], v[26:27], 0
v_mov_b32 v4, v25
s_nop 1
v_permlane16_swap_b32 v25, v4
v_add_f32 v25, v25, v4
v_mov_b32 v4, v25
s_nop 1
v_permlane32_swap_b32 v25, v4
v_add_f32 v25, v25, v4
ds_write_b64 v23, v[24:25] offset:41472
s_mov_b32 exec_lo, 0x00ff00ff
s_mov_b32 exec_hi, 0x00ff00ff
ds_write_b128 v21, v[80:83] offset:24576
ds_write_b128 v21, v[84:87] offset:24592
ds_write_b128 v21, v[88:91] offset:24608
ds_write_b128 v21, v[92:95] offset:24624
ds_write_b128 v21, v[96:99] offset:24640
ds_write_b128 v21, v[100:103] offset:24656
ds_write_b128 v21, v[104:107] offset:24672
ds_write_b128 v21, v[108:111] offset:24688
s_mov_b64 exec, 1
ds_add_u32 v1, v2 offset:64
s_mov_b64 exec, -1
SP19:
ds_read_b32 v4, v1 offset:64
s_waitcnt lgkmcnt(0)
v_readfirstlane_b32 s40, v4
s_sub_u32 s43, s43, 1
s_cbranch_scc1 EXIT
s_cmp_ge_u32 s40, 4
s_cbranch_scc1 SD20
s_branch SP19
SD20:
ds_read_b64 v[24:25], v9 offset:41472
ds_read_b64 v[26:27], v9 offset:41536
ds_read_b64 v[28:29], v9 offset:41600
ds_read_b64 v[30:31], v9 offset:41664
ds_read_b128 v[32:35], v22 offset:24576
ds_read_b128 v[36:39], v22 offset:28800
ds_read_b128 v[40:43], v22 offset:33024
ds_read_b128 v[44:47], v22 offset:37248
s_waitcnt lgkmcnt(4)
v_max3_f32 v48, v24, v26, v28
v_max_f32 v48, v48, v30
v_sub_f32 v24, v24, v48
v_sub_f32 v26, v26, v48
v_sub_f32 v28, v28, v48
v_sub_f32 v30, v30, v48
v_mul_f32 v24, 0x3fb8aa3b, v24
v_mul_f32 v26, 0x3fb8aa3b, v26
v_mul_f32 v28, 0x3fb8aa3b, v28
v_mul_f32 v30, 0x3fb8aa3b, v30
v_exp_f32 v24, v24
v_exp_f32 v26, v26
v_exp_f32 v28, v28
v_exp_f32 v30, v30
s_waitcnt lgkmcnt(0)
v_mul_f32 v49, v24, v25
v_mul_f32 v32, v24, v32
v_mul_f32 v33, v24, v33
v_mul_f32 v34, v24, v34
v_mul_f32 v35, v24, v35
v_fmac_f32 v32, v26, v36
v_fmac_f32 v33, v26, v37
v_fmac_f32 v34, v26, v38
v_fmac_f32 v35, v26, v39
v_fmac_f32 v49, v26, v27
v_fmac_f32 v32, v28, v40
v_fmac_f32 v33, v28, v41
v_fmac_f32 v34, v28, v42
v_fmac_f32 v35, v28, v43
v_fmac_f32 v49, v28, v29
v_fmac_f32 v32, v30, v44
v_fmac_f32 v33, v30, v45
v_fmac_f32 v34, v30, v46
v_fmac_f32 v35, v30, v47
v_fmac_f32 v49, v30, v31
v_and_or_b32 v32, v32, v3, s36
v_and_or_b32 v33, v33, v3, s37
v_and_or_b32 v34, v34, v3, s38
v_and_or_b32 v35, v35, v3, s39
global_store_dwordx4 v19, v[32:35], s[50:51] sc1
v_mov_b32 v50, 0
v_mov_b32 v51, 0
v_and_or_b32 v48, v48, v3, s36
v_and_or_b32 v49, v49, v3, s37
v_and_or_b32 v50, v50, v3, s38
v_and_or_b32 v51, v51, v3, s39
s_mov_b32 exec_lo, 0xff
s_mov_b32 exec_hi, 0xff
global_store_dwordx4 v19, v[48:51], s[50:51] offset:512 sc1
s_mov_b64 exec, 1
ds_add_u32 v1, v2 offset:36
s_mov_b64 exec, -1
s_cmp_ge_u32 s2, 224
s_cbranch_scc1 G1END
s_and_b32 s48, s2, 3
s_lshl_b32 s48, s48, 10
s_lshl_b32 s49, s34, 8
s_add_u32 s48, s48, s49
s_add_u32 s48, s48, 73728
s_add_u32 s12, s30, s48
s_addc_u32 s13, s31, 0
s_add_u32 s14, s12, 8704
s_addc_u32 s15, s13, 0
v_mul_u32_u24 v18, 17408, v13
v_lshl_add_u32 v18, v12, 4, v18
v_add_u32 v19, 4352, v18
v_lshl_add_u32 v14, v12, 2, v13
s_lshl_b32 s48, s34, 6
v_add_u32 v14, s48, v14
v_lshlrev_b32 v14, 2, v14
SP21:
ds_read_b32 v4, v1 offset:44
s_waitcnt lgkmcnt(0)
v_readfirstlane_b32 s40, v4
s_sub_u32 s43, s43, 1
s_cbranch_scc1 EXIT
s_cmp_ge_u32 s40, 1
s_cbranch_scc1 SD22
s_branch SP21
SD22:
s_waitcnt vmcnt(0)
s_mov_b64 s[44:45], -1
s_mov_b64 s[46:47], -1
s_mov_b64 s[48:49], -1
s_mov_b64 s[50:51], -1
s_mov_b32 s33, 0
G23:
s_mov_b64 exec, s[44:45]
global_load_dwordx4 v[32:35], v18, s[12:13] offset:0 sc1
s_mov_b64 exec, s[46:47]
global_load_dwordx4 v[36:39], v19, s[12:13] offset:0 sc1
s_mov_b64 exec, s[48:49]
global_load_dwordx4 v[40:43], v18, s[14:15] offset:0 sc1
s_mov_b64 exec, s[50:51]
global_load_dwordx4 v[44:47], v19, s[14:15] offset:0 sc1
s_mov_b64 exec, -1
s_mov_b64 vcc, 0
s_cmp_eq_u32 s33, 0
s_cbranch_scc1 K28
s_waitcnt vmcnt(0)
K28:
s_mov_b32 s33, 1
s_waitcnt vmcnt(3)
v_perm_b32 v4, v33, v32, s41
v_perm_b32 v6, v35, v34, s42
v_or_b32 v4, v4, v6
v_cmp_ne_u32 s[44:45], s35, v4
s_waitcnt vmcnt(2)
v_perm_b32 v4, v37, v36, s41
v_perm_b32 v6, v39, v38, s42
v_or_b32 v4, v4, v6
v_cmp_ne_u32 s[46:47], s35, v4
s_waitcnt vmcnt(1)
v_perm_b32 v4, v41, v40, s41
v_perm_b32 v6, v43, v42, s42
v_or_b32 v4, v4, v6
v_cmp_ne_u32 s[48:49], s35, v4
s_waitcnt vmcnt(0)
v_perm_b32 v4, v45, v44, s41
v_perm_b32 v6, v47, v46, s42
v_or_b32 v4, v4, v6
v_cmp_ne_u32 s[50:51], s35, v4
s_sub_u32 s43, s43, 64
s_cbranch_scc1 EXIT
s_or_b64 vcc, vcc, s[44:45]
s_or_b64 vcc, vcc, s[46:47]
s_or_b64 vcc, vcc, s[48:49]
s_or_b64 vcc, vcc, s[50:51]
s_cbranch_scc1 G23
G23x:
s_mov_b64 exec, -1
s_nop 1
v_permlane32_swap_b32 v32, v34
v_permlane32_swap_b32 v33, v35
v_add_f32 v32, v32, v34
v_add_f32 v33, v33, v35
s_nop 1
v_permlane16_swap_b32 v32, v33
v_add_f32 v32, v32, v33
s_nop 1
v_permlane32_swap_b32 v36, v38
v_permlane32_swap_b32 v37, v39
v_add_f32 v36, v36, v38
v_add_f32 v37, v37, v39
s_nop 1
v_permlane16_swap_b32 v36, v37
v_add_f32 v36, v36, v37
s_nop 1
v_permlane32_swap_b32 v40, v42
v_permlane32_swap_b32 v41, v43
v_add_f32 v40, v40, v42
v_add_f32 v41, v41, v43
s_nop 1
v_permlane16_swap_b32 v40, v41
v_add_f32 v40, v40, v41
s_nop 1
v_permlane32_swap_b32 v44, v46
v_permlane32_swap_b32 v45, v47
v_add_f32 v44, v44, v46
v_add_f32 v45, v45, v47
s_nop 1
v_permlane16_swap_b32 v44, v45
v_add_f32 v44, v44, v45
v_cvt_pk_bf16_f32 v32, 0, v32
v_cvt_pk_bf16_f32 v36, 0, v36
v_cvt_pk_bf16_f32 v40, 0, v40
v_cvt_pk_bf16_f32 v44, 0, v44
v_add_f32 v23, 1.0, v40
v_cvt_pk_bf16_f32 v23, v23, 0
v_lshrrev_b32 v36, 16, v36
ds_write_b32 v14, v23 offset:8192
ds_write_b32 v14, v36 offset:9216
ds_write_b32 v14, v32 offset:4352
ds_write_b32 v14, v44 offset:11264
s_mov_b64 exec, 1
ds_add_u32 v1, v2 offset:20
s_mov_b64 exec, -1
G1END:
s_endpgm
G2:
s_and_b32 s45, s2, 3
s_lshr_b32 s44, s2, 2
v_lshrrev_b32 v8, 3, v0
v_and_b32 v9, 7, v0
v_lshlrev_b32 v9, 4, v9
s_lshl_b32 s46, s45, 8
s_lshl_b32 s47, s34, 6
s_add_u32 s46, s46, s47
s_mul_i32 s46, s46, 7168
s_lshl_b32 s47, s44, 7
s_add_u32 s46, s46, s47
s_add_u32 s16, s16, s46
s_addc_u32 s17, s17, 0
s_add_u32 s18, s18, s46
s_addc_u32 s19, s19, 0
v_mul_u32_u24 v10, 57344, v8
v_add_u32 v10, v10, v9
s_mul_i32 s48, s45, 14336
s_lshl_b32 s49, s44, 8
s_add_u32 s48, s48, s49
s_add_u32 s48, s48, 458752
s_add_u32 s50, s30, s48
s_addc_u32 s51, s31, 0
v_lshrrev_b32 v15, 4, v0
v_mul_u32_u24 v15, 57344, v15
v_and_b32 v12, 15, v0
v_lshl_add_u32 v15, v12, 4, v15
v_add_u32 v12, 172032, v15
v_and_b32 v13, 7, v0
v_lshlrev_b32 v13, 5, v13
v_lshrrev_b32 v4, 4, v0
v_lshl_add_u32 v13, v4, 3, v13
s_mul_i32 s40, s34, 1536
v_add_u32 v13, s40, v13
s_lshl_b32 s48, s34, 8
v_lshlrev_b32 v14, 5, v8
v_add_u32 v14, s48, v14
s_and_b32 s44, s2, 63
s_lshr_b32 s45, s2, 6
s_lshl_b32 s46, s45, 8
s_lshl_b32 s47, s34, 6
s_add_u32 s46, s46, s47
s_lshl_b32 s47, s46, 1
s_add_u32 s22, s22, s47
s_addc_u32 s23, s23, 0
v_lshlrev_b32 v11, 4, v8
global_load_dwordx4 v[24:27], v11, s[22:23]
s_mul_i32 s46, s46, 12288
s_lshl_b32 s47, s44, 7
s_add_u32 s46, s46, s47
s_add_u32 s46, s46, 4096
s_add_u32 s24, s24, s46
s_addc_u32 s25, s25, 0
v_mul_u32_u24 v11, 0x18000, v8
v_add_u32 v11, v11, v9
s_mul_i32 s48, s45, 17408
s_lshl_b32 s49, s44, 8
s_add_u32 s48, s48, s49
s_lshr_b32 s49, s44, 4
s_lshl_b32 s49, s49, 8
s_add_u32 s48, s48, s49
s_add_u32 s48, s48, 73728
s_add_u32 s52, s30, s48
s_addc_u32 s53, s31, 0
v_and_b32 v6, 7, v0
v_lshlrev_b32 v6, 5, v6
v_lshrrev_b32 v4, 4, v0
v_lshl_add_u32 v6, v4, 3, v6
s_mul_i32 s40, s34, 256
v_add_u32 v6, s40, v6
s_waitcnt lgkmcnt(0)
s_barrier
s_add_u32 s35, s35, 1
s_and_b32 s36, s35, 0xff
s_bfe_u32 s37, s35, 0x80008
s_bfe_u32 s38, s35, 0x80010
s_lshr_b32 s39, s35, 24
s_waitcnt vmcnt(0)
v_and_b32 v97, 0xffff0000, v24
v_lshlrev_b32 v96, 16, v24
v_and_b32 v99, 0xffff0000, v25
v_lshlrev_b32 v98, 16, v25
v_and_b32 v101, 0xffff0000, v26
v_lshlrev_b32 v100, 16, v26
v_and_b32 v103, 0xffff0000, v27
v_lshlrev_b32 v102, 16, v27
v_mul_f32 v4, 0xbfb8aa3b, v96
v_exp_f32 v4, v4
s_nop 0
v_add_f32 v4, 1.0, v4
v_rcp_f32 v4, v4
s_nop 0
v_mul_f32 v96, v96, v4
v_cvt_pk_bf16_f32 v96, v96, 0
v_mul_f32 v4, 0xbfb8aa3b, v97
v_exp_f32 v4, v4
s_nop 0
v_add_f32 v4, 1.0, v4
v_rcp_f32 v4, v4
s_nop 0
v_mul_f32 v97, v97, v4
v_cvt_pk_bf16_f32 v97, v97, 0
v_mul_f32 v4, 0xbfb8aa3b, v98
v_exp_f32 v4, v4
s_nop 0
v_add_f32 v4, 1.0, v4
v_rcp_f32 v4, v4
s_nop 0
v_mul_f32 v98, v98, v4
v_cvt_pk_bf16_f32 v98, v98, 0
v_mul_f32 v4, 0xbfb8aa3b, v99
v_exp_f32 v4, v4
s_nop 0
v_add_f32 v4, 1.0, v4
v_rcp_f32 v4, v4
s_nop 0
v_mul_f32 v99, v99, v4
v_cvt_pk_bf16_f32 v99, v99, 0
v_mul_f32 v4, 0xbfb8aa3b, v100
v_exp_f32 v4, v4
s_nop 0
v_add_f32 v4, 1.0, v4
v_rcp_f32 v4, v4
s_nop 0
v_mul_f32 v100, v100, v4
v_cvt_pk_bf16_f32 v100, v100, 0
v_mul_f32 v4, 0xbfb8aa3b, v101
v_exp_f32 v4, v4
s_nop 0
v_add_f32 v4, 1.0, v4
v_rcp_f32 v4, v4
s_nop 0
v_mul_f32 v101, v101, v4
v_cvt_pk_bf16_f32 v101, v101, 0
v_mul_f32 v4, 0xbfb8aa3b, v102
v_exp_f32 v4, v4
s_nop 0
v_add_f32 v4, 1.0, v4
v_rcp_f32 v4, v4
s_nop 0
v_mul_f32 v102, v102, v4
v_cvt_pk_bf16_f32 v102, v102, 0
v_mul_f32 v4, 0xbfb8aa3b, v103
v_exp_f32 v4, v4
s_nop 0
v_add_f32 v4, 1.0, v4
v_rcp_f32 v4, v4
s_nop 0
v_mul_f32 v103, v103, v4
v_cvt_pk_bf16_f32 v103, v103, 0
v_mov_b32 v16, 0
v_mov_b32 v17, 0
v_mov_b32 v18, 0
v_mov_b32 v19, 0
v_mov_b32 v20, 0
v_mov_b32 v21, 0
v_mov_b32 v22, 0
v_mov_b32 v23, 0
v_mov_b32 v24, 0
v_mov_b32 v25, 0
v_mov_b32 v26, 0
v_mov_b32 v27, 0
v_mov_b32 v28, 0
v_mov_b32 v29, 0
v_mov_b32 v30, 0
v_mov_b32 v31, 0
v_mov_b32 v32, 0
v_mov_b32 v33, 0
v_mov_b32 v34, 0
v_mov_b32 v35, 0
v_mov_b32 v36, 0
v_mov_b32 v37, 0
v_mov_b32 v38, 0
v_mov_b32 v39, 0
v_mov_b32 v40, 0
v_mov_b32 v41, 0
v_mov_b32 v42, 0
v_mov_b32 v43, 0
v_mov_b32 v44, 0
v_mov_b32 v45, 0
v_mov_b32 v46, 0
v_mov_b32 v47, 0
v_mov_b32 v48, 0
v_mov_b32 v49, 0
v_mov_b32 v50, 0
v_mov_b32 v51, 0
v_mov_b32 v52, 0
v_mov_b32 v53, 0
v_mov_b32 v54, 0
v_mov_b32 v55, 0
v_mov_b32 v56, 0
v_mov_b32 v57, 0
v_mov_b32 v58, 0
v_mov_b32 v59, 0
v_mov_b32 v60, 0
v_mov_b32 v61, 0
v_mov_b32 v62, 0
v_mov_b32 v63, 0
SP29:
ds_read_b32 v4, v7 offset:144
s_waitcnt lgkmcnt(0)
v_readfirstlane_b32 s40, v4
s_sub_u32 s43, s43, 1
s_cbranch_scc1 EXIT
s_cmp_ge_u32 s40, 1
s_cbranch_scc1 SD30
s_sleep 1
s_branch SP29
SD30:
global_load_dwordx4 v[64:67], v11, s[24:25] nt
s_add_u32 s24, s24, 12288
s_addc_u32 s25, s25, 0
s_waitcnt vmcnt(3)
global_load_dwordx4 v[68:71], v11, s[24:25] nt
s_add_u32 s24, s24, 12288
s_addc_u32 s25, s25, 0
s_waitcnt vmcnt(3)
global_load_dwordx4 v[72:75], v11, s[24:25] nt
s_add_u32 s24, s24, 12288
s_addc_u32 s25, s25, 0
s_waitcnt vmcnt(3)
global_load_dwordx4 v[76:79], v11, s[24:25] nt
s_add_u32 s24, s24, 12288
s_addc_u32 s25, s25, 0
s_waitcnt vmcnt(3)
global_load_dwordx4 v[80:83], v11, s[24:25] nt
s_add_u32 s24, s24, 12288
s_addc_u32 s25, s25, 0
s_waitcnt vmcnt(3)
global_load_dwordx4 v[84:87], v11, s[24:25] nt
s_add_u32 s24, s24, 12288
s_addc_u32 s25, s25, 0
s_waitcnt vmcnt(3)
global_load_dwordx4 v[88:91], v11, s[24:25] nt
s_add_u32 s24, s24, 12288
s_addc_u32 s25, s25, 0
s_waitcnt vmcnt(3)
global_load_dwordx4 v[92:95], v11, s[24:25] nt
s_waitcnt vmcnt(3)
s_waitcnt vmcnt(1)
s_mov_b64 exec, 1
ds_add_u32 v7, v2 offset:176
s_mov_b64 exec, -1
v_mov_b32 v112, 0
v_mov_b32 v113, 0
v_mov_b32 v114, 0
v_mov_b32 v115, 0
v_mov_b32 v116, 0
v_mov_b32 v117, 0
v_mov_b32 v118, 0
v_mov_b32 v119, 0
s_waitcnt vmcnt(0)
v_lshlrev_b32 v4, 16, v96
v_dot2c_f32_bf16 v112, v64, v96
v_dot2c_f32_bf16 v114, v65, v96
v_dot2c_f32_bf16 v116, v66, v96
v_dot2c_f32_bf16 v118, v67, v96
v_dot2c_f32_bf16 v113, v64, v4
v_dot2c_f32_bf16 v115, v65, v4
v_dot2c_f32_bf16 v117, v66, v4
v_dot2c_f32_bf16 v119, v67, v4
v_lshlrev_b32 v4, 16, v97
v_dot2c_f32_bf16 v112, v68, v97
v_dot2c_f32_bf16 v114, v69, v97
v_dot2c_f32_bf16 v116, v70, v97
v_dot2c_f32_bf16 v118, v71, v97
v_dot2c_f32_bf16 v113, v68, v4
v_dot2c_f32_bf16 v115, v69, v4
v_dot2c_f32_bf16 v117, v70, v4
v_dot2c_f32_bf16 v119, v71, v4
v_lshlrev_b32 v4, 16, v98
v_dot2c_f32_bf16 v112, v72, v98
v_dot2c_f32_bf16 v114, v73, v98
v_dot2c_f32_bf16 v116, v74, v98
v_dot2c_f32_bf16 v118, v75, v98
v_dot2c_f32_bf16 v113, v72, v4
v_dot2c_f32_bf16 v115, v73, v4
v_dot2c_f32_bf16 v117, v74, v4
v_dot2c_f32_bf16 v119, v75, v4
v_lshlrev_b32 v4, 16, v99
v_dot2c_f32_bf16 v112, v76, v99
v_dot2c_f32_bf16 v114, v77, v99
v_dot2c_f32_bf16 v116, v78, v99
v_dot2c_f32_bf16 v118, v79, v99
v_dot2c_f32_bf16 v113, v76, v4
v_dot2c_f32_bf16 v115, v77, v4
v_dot2c_f32_bf16 v117, v78, v4
v_dot2c_f32_bf16 v119, v79, v4
v_lshlrev_b32 v4, 16, v100
v_dot2c_f32_bf16 v112, v80, v100
v_dot2c_f32_bf16 v114, v81, v100
v_dot2c_f32_bf16 v116, v82, v100
v_dot2c_f32_bf16 v118, v83, v100
v_dot2c_f32_bf16 v113, v80, v4
v_dot2c_f32_bf16 v115, v81, v4
v_dot2c_f32_bf16 v117, v82, v4
v_dot2c_f32_bf16 v119, v83, v4
v_lshlrev_b32 v4, 16, v101
v_dot2c_f32_bf16 v112, v84, v101
v_dot2c_f32_bf16 v114, v85, v101
v_dot2c_f32_bf16 v116, v86, v101
v_dot2c_f32_bf16 v118, v87, v101
v_dot2c_f32_bf16 v113, v84, v4
v_dot2c_f32_bf16 v115, v85, v4
v_dot2c_f32_bf16 v117, v86, v4
v_dot2c_f32_bf16 v119, v87, v4
v_lshlrev_b32 v4, 16, v102
v_dot2c_f32_bf16 v112, v88, v102
v_dot2c_f32_bf16 v114, v89, v102
v_dot2c_f32_bf16 v116, v90, v102
v_dot2c_f32_bf16 v118, v91, v102
v_dot2c_f32_bf16 v113, v88, v4
v_dot2c_f32_bf16 v115, v89, v4
v_dot2c_f32_bf16 v117, v90, v4
v_dot2c_f32_bf16 v119, v91, v4
v_lshlrev_b32 v4, 16, v103
v_dot2c_f32_bf16 v112, v92, v103
v_dot2c_f32_bf16 v114, v93, v103
v_dot2c_f32_bf16 v116, v94, v103
v_dot2c_f32_bf16 v118, v95, v103
v_dot2c_f32_bf16 v113, v92, v4
v_dot2c_f32_bf16 v115, v93, v4
v_dot2c_f32_bf16 v117, v94, v4
v_dot2c_f32_bf16 v119, v95, v4
s_nop 2
v_permlane32_swap_b32 v112, v116
v_permlane32_swap_b32 v113, v117
v_permlane32_swap_b32 v114, v118
v_permlane32_swap_b32 v115, v119
v_add_f32 v112, v112, v116
v_add_f32 v113, v113, v117
v_add_f32 v114, v114, v118
v_add_f32 v115, v115, v119
s_nop 0
v_permlane16_swap_b32 v112, v114
v_permlane16_swap_b32 v113, v115
v_add_f32 v112, v112, v114
v_add_f32 v113, v113, v115
s_nop 0
v_add_f32_dpp v112, v112, v112 row_ror:8 row_mask:0xf bank_mask:0xf
v_add_f32_dpp v113, v113, v113 row_ror:8 row_mask:0xf bank_mask:0xf
ds_write_b64 v6, v[112:113] offset:15360
s_mov_b64 exec, 1
ds_add_rtn_u32 v4, v1, v2 offset:72
s_mov_b64 exec, -1
s_waitcnt lgkmcnt(0)
v_readfirstlane_b32 s40, v4
s_cmp_lg_u32 s40, 3
s_cbranch_scc1 LP31
LP31x:
s_mov_b32 exec_lo, 0xffff
s_mov_b32 exec_hi, 0x0
ds_read_b128 v[112:115], v5 offset:15360
ds_read_b128 v[116:119], v5 offset:15616
ds_read_b128 v[120:123], v5 offset:15872
ds_read_b128 v[124:127], v5 offset:16128
s_waitcnt lgkmcnt(2)
v_add_f32 v112, v112, v116
v_add_f32 v113, v113, v117
v_add_f32 v114, v114, v118
v_add_f32 v115, v115, v119
s_waitcnt lgkmcnt(0)
v_add_f32 v120, v120, v124
v_add_f32 v121, v121, v125
v_add_f32 v122, v122, v126
v_add_f32 v123, v123, v127
v_add_f32 v112, v112, v120
v_add_f32 v113, v113, v121
v_add_f32 v114, v114, v122
v_add_f32 v115, v115, v123
v_and_or_b32 v112, v112, v3, s36
v_and_or_b32 v113, v113, v3, s37
v_and_or_b32 v114, v114, v3, s38
v_and_or_b32 v115, v115, v3, s39
global_store_dwordx4 v5, v[112:115], s[52:53] sc1
s_mov_b64 exec, -1
s_mov_b64 exec, 1
ds_add_u32 v1, v2 offset:44
s_mov_b64 exec, -1
LP31:
SP32:
ds_read_b32 v4, v7 offset:192
s_waitcnt lgkmcnt(0)
v_readfirstlane_b32 s40, v4
s_sub_u32 s43, s43, 1
s_cbranch_scc1 EXIT
s_cmp_ge_u32 s40, 1
s_cbranch_scc1 SD33
s_sleep 1
s_branch SP32
SD33:
s_cmp_ge_u32 s2, 224
s_cbranch_scc0 G2W
s_mov_b64 exec, 1
ds_add_u32 v7, v2 offset:160
s_mov_b64 exec, -1
s_endpgm
G2W:
global_load_dwordx4 v[64:67], v10, s[16:17] nt
s_add_u32 s16, s16, 7168
s_addc_u32 s17, s17, 0
s_waitcnt vmcnt(3)
global_load_dwordx4 v[68:71], v10, s[18:19] nt
s_add_u32 s18, s18, 7168
s_addc_u32 s19, s19, 0
s_waitcnt vmcnt(3)
global_load_dwordx4 v[72:75], v10, s[16:17] nt
s_add_u32 s16, s16, 7168
s_addc_u32 s17, s17, 0
s_waitcnt vmcnt(3)
global_load_dwordx4 v[76:79], v10, s[18:19] nt
s_add_u32 s18, s18, 7168
s_addc_u32 s19, s19, 0
s_waitcnt vmcnt(3)
global_load_dwordx4 v[80:83], v10, s[16:17] nt
s_add_u32 s16, s16, 7168
s_addc_u32 s17, s17, 0
s_waitcnt vmcnt(3)
global_load_dwordx4 v[84:87], v10, s[18:19] nt
s_add_u32 s18, s18, 7168
s_addc_u32 s19, s19, 0
s_waitcnt vmcnt(3)
global_load_dwordx4 v[88:91], v10, s[16:17] nt
s_add_u32 s16, s16, 7168
s_addc_u32 s17, s17, 0
s_waitcnt vmcnt(3)
global_load_dwordx4 v[92:95], v10, s[18:19] nt
s_add_u32 s18, s18, 7168
s_addc_u32 s19, s19, 0
s_waitcnt vmcnt(3)
global_load_dwordx4 v[96:99], v10, s[16:17] nt
s_add_u32 s16, s16, 7168
s_addc_u32 s17, s17, 0
s_waitcnt vmcnt(3)
global_load_dwordx4 v[100:103], v10, s[18:19] nt
s_add_u32 s18, s18, 7168
s_addc_u32 s19, s19, 0
s_waitcnt vmcnt(3)
global_load_dwordx4 v[104:107], v10, s[16:17] nt
s_add_u32 s16, s16, 7168
s_addc_u32 s17, s17, 0
s_waitcnt vmcnt(3)
global_load_dwordx4 v[108:111], v10, s[18:19] nt
s_add_u32 s18, s18, 7168
s_addc_u32 s19, s19, 0
s_waitcnt vmcnt(3)
global_load_dwordx4 v[112:115], v10, s[16:17] nt
s_add_u32 s16, s16, 7168
s_addc_u32 s17, s17, 0
s_waitcnt vmcnt(3)
global_load_dwordx4 v[116:119], v10, s[18:19] nt
s_add_u32 s18, s18, 7168
s_addc_u32 s19, s19, 0
s_waitcnt vmcnt(3)
global_load_dwordx4 v[120:123], v10, s[16:17] nt
s_waitcnt vmcnt(3)
global_load_dwordx4 v[124:127], v10, s[18:19] nt
s_waitcnt vmcnt(3)
s_waitcnt vmcnt(1)
s_mov_b64 exec, 1
ds_add_u32 v7, v2 offset:160
s_mov_b64 exec, -1
SP34:
ds_read_b32 v4, v1 offset:20
s_waitcnt lgkmcnt(0)
v_readfirstlane_b32 s40, v4
s_sub_u32 s43, s43, 1
s_cbranch_scc1 EXIT
s_cmp_ge_u32 s40, 4
s_cbranch_scc1 SD35
s_branch SP34
SD35:
s_waitcnt vmcnt(2)
ds_read_b128 v[8:11], v14 offset:8192
s_waitcnt lgkmcnt(0)
v_lshlrev_b32 v4, 16, v8
v_dot2c_f32_bf16 v32, v64, v8
v_dot2c_f32_bf16 v34, v65, v8
v_dot2c_f32_bf16 v36, v66, v8
v_dot2c_f32_bf16 v38, v67, v8
v_dot2c_f32_bf16 v33, v64, v4
v_dot2c_f32_bf16 v35, v65, v4
v_dot2c_f32_bf16 v37, v66, v4
v_dot2c_f32_bf16 v39, v67, v4
v_dot2c_f32_bf16 v40, v68, v8
v_dot2c_f32_bf16 v42, v69, v8
v_dot2c_f32_bf16 v44, v70, v8
v_dot2c_f32_bf16 v46, v71, v8
v_dot2c_f32_bf16 v41, v68, v4
v_dot2c_f32_bf16 v43, v69, v4
v_dot2c_f32_bf16 v45, v70, v4
v_dot2c_f32_bf16 v47, v71, v4
v_lshlrev_b32 v4, 16, v9
v_dot2c_f32_bf16 v32, v72, v9
v_dot2c_f32_bf16 v34, v73, v9
v_dot2c_f32_bf16 v36, v74, v9
v_dot2c_f32_bf16 v38, v75, v9
v_dot2c_f32_bf16 v33, v72, v4
v_dot2c_f32_bf16 v35, v73, v4
v_dot2c_f32_bf16 v37, v74, v4
v_dot2c_f32_bf16 v39, v75, v4
v_dot2c_f32_bf16 v40, v76, v9
v_dot2c_f32_bf16 v42, v77, v9
v_dot2c_f32_bf16 v44, v78, v9
v_dot2c_f32_bf16 v46, v79, v9
v_dot2c_f32_bf16 v41, v76, v4
v_dot2c_f32_bf16 v43, v77, v4
v_dot2c_f32_bf16 v45, v78, v4
v_dot2c_f32_bf16 v47, v79, v4
v_lshlrev_b32 v4, 16, v10
v_dot2c_f32_bf16 v32, v80, v10
v_dot2c_f32_bf16 v34, v81, v10
v_dot2c_f32_bf16 v36, v82, v10
v_dot2c_f32_bf16 v38, v83, v10
v_dot2c_f32_bf16 v33, v80, v4
v_dot2c_f32_bf16 v35, v81, v4
v_dot2c_f32_bf16 v37, v82, v4
v_dot2c_f32_bf16 v39, v83, v4
v_dot2c_f32_bf16 v40, v84, v10
v_dot2c_f32_bf16 v42, v85, v10
v_dot2c_f32_bf16 v44, v86, v10
v_dot2c_f32_bf16 v46, v87, v10
v_dot2c_f32_bf16 v41, v84, v4
v_dot2c_f32_bf16 v43, v85, v4
v_dot2c_f32_bf16 v45, v86, v4
v_dot2c_f32_bf16 v47, v87, v4
v_lshlrev_b32 v4, 16, v11
v_dot2c_f32_bf16 v32, v88, v11
v_dot2c_f32_bf16 v34, v89, v11
v_dot2c_f32_bf16 v36, v90, v11
v_dot2c_f32_bf16 v38, v91, v11
v_dot2c_f32_bf16 v33, v88, v4
v_dot2c_f32_bf16 v35, v89, v4
v_dot2c_f32_bf16 v37, v90, v4
v_dot2c_f32_bf16 v39, v91, v4
v_dot2c_f32_bf16 v40, v92, v11
v_dot2c_f32_bf16 v42, v93, v11
v_dot2c_f32_bf16 v44, v94, v11
v_dot2c_f32_bf16 v46, v95, v11
v_dot2c_f32_bf16 v41, v92, v4
v_dot2c_f32_bf16 v43, v93, v4
v_dot2c_f32_bf16 v45, v94, v4
v_dot2c_f32_bf16 v47, v95, v4
ds_read_b128 v[8:11], v14 offset:8208
s_waitcnt lgkmcnt(0)
v_lshlrev_b32 v4, 16, v8
v_dot2c_f32_bf16 v32, v96, v8
v_dot2c_f32_bf16 v34, v97, v8
v_dot2c_f32_bf16 v36, v98, v8
v_dot2c_f32_bf16 v38, v99, v8
v_dot2c_f32_bf16 v33, v96, v4
v_dot2c_f32_bf16 v35, v97, v4
v_dot2c_f32_bf16 v37, v98, v4
v_dot2c_f32_bf16 v39, v99, v4
v_dot2c_f32_bf16 v40, v100, v8
v_dot2c_f32_bf16 v42, v101, v8
v_dot2c_f32_bf16 v44, v102, v8
v_dot2c_f32_bf16 v46, v103, v8
v_dot2c_f32_bf16 v41, v100, v4
v_dot2c_f32_bf16 v43, v101, v4
v_dot2c_f32_bf16 v45, v102, v4
v_dot2c_f32_bf16 v47, v103, v4
v_lshlrev_b32 v4, 16, v9
v_dot2c_f32_bf16 v32, v104, v9
v_dot2c_f32_bf16 v34, v105, v9
v_dot2c_f32_bf16 v36, v106, v9
v_dot2c_f32_bf16 v38, v107, v9
v_dot2c_f32_bf16 v33, v104, v4
v_dot2c_f32_bf16 v35, v105, v4
v_dot2c_f32_bf16 v37, v106, v4
v_dot2c_f32_bf16 v39, v107, v4
v_dot2c_f32_bf16 v40, v108, v9
v_dot2c_f32_bf16 v42, v109, v9
v_dot2c_f32_bf16 v44, v110, v9
v_dot2c_f32_bf16 v46, v111, v9
v_dot2c_f32_bf16 v41, v108, v4
v_dot2c_f32_bf16 v43, v109, v4
v_dot2c_f32_bf16 v45, v110, v4
v_dot2c_f32_bf16 v47, v111, v4
v_lshlrev_b32 v4, 16, v10
v_dot2c_f32_bf16 v32, v112, v10
v_dot2c_f32_bf16 v34, v113, v10
v_dot2c_f32_bf16 v36, v114, v10
v_dot2c_f32_bf16 v38, v115, v10
v_dot2c_f32_bf16 v33, v112, v4
v_dot2c_f32_bf16 v35, v113, v4
v_dot2c_f32_bf16 v37, v114, v4
v_dot2c_f32_bf16 v39, v115, v4
v_dot2c_f32_bf16 v40, v116, v10
v_dot2c_f32_bf16 v42, v117, v10
v_dot2c_f32_bf16 v44, v118, v10
v_dot2c_f32_bf16 v46, v119, v10
v_dot2c_f32_bf16 v41, v116, v4
v_dot2c_f32_bf16 v43, v117, v4
v_dot2c_f32_bf16 v45, v118, v4
v_dot2c_f32_bf16 v47, v119, v4
s_waitcnt vmcnt(0)
v_lshlrev_b32 v4, 16, v11
v_dot2c_f32_bf16 v32, v120, v11
v_dot2c_f32_bf16 v34, v121, v11
v_dot2c_f32_bf16 v36, v122, v11
v_dot2c_f32_bf16 v38, v123, v11
v_dot2c_f32_bf16 v33, v120, v4
v_dot2c_f32_bf16 v35, v121, v4
v_dot2c_f32_bf16 v37, v122, v4
v_dot2c_f32_bf16 v39, v123, v4
v_dot2c_f32_bf16 v40, v124, v11
v_dot2c_f32_bf16 v42, v125, v11
v_dot2c_f32_bf16 v44, v126, v11
v_dot2c_f32_bf16 v46, v127, v11
v_dot2c_f32_bf16 v41, v124, v4
v_dot2c_f32_bf16 v43, v125, v4
v_dot2c_f32_bf16 v45, v126, v4
v_dot2c_f32_bf16 v47, v127, v4
s_nop 2
v_permlane32_swap_b32 v32, v36
v_permlane32_swap_b32 v33, v37
v_permlane32_swap_b32 v34, v38
v_permlane32_swap_b32 v35, v39
v_add_f32 v32, v32, v36
v_add_f32 v33, v33, v37
v_add_f32 v34, v34, v38
v_add_f32 v35, v35, v39
s_nop 0
v_permlane16_swap_b32 v32, v34
v_permlane16_swap_b32 v33, v35
v_add_f32 v32, v32, v34
v_add_f32 v33, v33, v35
s_nop 0
v_add_f32_dpp v32, v32, v32 row_ror:8 row_mask:0xf bank_mask:0xf
v_add_f32_dpp v33, v33, v33 row_ror:8 row_mask:0xf bank_mask:0xf
ds_write_b64 v13, v[32:33] offset:18944
s_nop 2
v_permlane32_swap_b32 v40, v44
v_permlane32_swap_b32 v41, v45
v_permlane32_swap_b32 v42, v46
v_permlane32_swap_b32 v43, v47
v_add_f32 v40, v40, v44
v_add_f32 v41, v41, v45
v_add_f32 v42, v42, v46
v_add_f32 v43, v43, v47
s_nop 0
v_permlane16_swap_b32 v40, v42
v_permlane16_swap_b32 v41, v43
v_add_f32 v40, v40, v42
v_add_f32 v41, v41, v43
s_nop 0
v_add_f32_dpp v40, v40, v40 row_ror:8 row_mask:0xf bank_mask:0xf
v_add_f32_dpp v41, v41, v41 row_ror:8 row_mask:0xf bank_mask:0xf
ds_write_b64 v13, v[40:41] offset:19200
ds_read_b128 v[8:11], v14 offset:9216
s_waitcnt lgkmcnt(0)
v_lshlrev_b32 v4, 16, v8
v_dot2c_f32_bf16 v48, v64, v8
v_dot2c_f32_bf16 v50, v65, v8
v_dot2c_f32_bf16 v52, v66, v8
v_dot2c_f32_bf16 v54, v67, v8
v_dot2c_f32_bf16 v49, v64, v4
v_dot2c_f32_bf16 v51, v65, v4
v_dot2c_f32_bf16 v53, v66, v4
v_dot2c_f32_bf16 v55, v67, v4
v_dot2c_f32_bf16 v56, v68, v8
v_dot2c_f32_bf16 v58, v69, v8
v_dot2c_f32_bf16 v60, v70, v8
v_dot2c_f32_bf16 v62, v71, v8
v_dot2c_f32_bf16 v57, v68, v4
v_dot2c_f32_bf16 v59, v69, v4
v_dot2c_f32_bf16 v61, v70, v4
v_dot2c_f32_bf16 v63, v71, v4
v_lshlrev_b32 v4, 16, v9
v_dot2c_f32_bf16 v48, v72, v9
v_dot2c_f32_bf16 v50, v73, v9
v_dot2c_f32_bf16 v52, v74, v9
v_dot2c_f32_bf16 v54, v75, v9
v_dot2c_f32_bf16 v49, v72, v4
v_dot2c_f32_bf16 v51, v73, v4
v_dot2c_f32_bf16 v53, v74, v4
v_dot2c_f32_bf16 v55, v75, v4
v_dot2c_f32_bf16 v56, v76, v9
v_dot2c_f32_bf16 v58, v77, v9
v_dot2c_f32_bf16 v60, v78, v9
v_dot2c_f32_bf16 v62, v79, v9
v_dot2c_f32_bf16 v57, v76, v4
v_dot2c_f32_bf16 v59, v77, v4
v_dot2c_f32_bf16 v61, v78, v4
v_dot2c_f32_bf16 v63, v79, v4
v_lshlrev_b32 v4, 16, v10
v_dot2c_f32_bf16 v48, v80, v10
v_dot2c_f32_bf16 v50, v81, v10
v_dot2c_f32_bf16 v52, v82, v10
v_dot2c_f32_bf16 v54, v83, v10
v_dot2c_f32_bf16 v49, v80, v4
v_dot2c_f32_bf16 v51, v81, v4
v_dot2c_f32_bf16 v53, v82, v4
v_dot2c_f32_bf16 v55, v83, v4
v_dot2c_f32_bf16 v56, v84, v10
v_dot2c_f32_bf16 v58, v85, v10
v_dot2c_f32_bf16 v60, v86, v10
v_dot2c_f32_bf16 v62, v87, v10
v_dot2c_f32_bf16 v57, v84, v4
v_dot2c_f32_bf16 v59, v85, v4
v_dot2c_f32_bf16 v61, v86, v4
v_dot2c_f32_bf16 v63, v87, v4
v_lshlrev_b32 v4, 16, v11
v_dot2c_f32_bf16 v48, v88, v11
v_dot2c_f32_bf16 v50, v89, v11
v_dot2c_f32_bf16 v52, v90, v11
v_dot2c_f32_bf16 v54, v91, v11
v_dot2c_f32_bf16 v49, v88, v4
v_dot2c_f32_bf16 v51, v89, v4
v_dot2c_f32_bf16 v53, v90, v4
v_dot2c_f32_bf16 v55, v91, v4
v_dot2c_f32_bf16 v56, v92, v11
v_dot2c_f32_bf16 v58, v93, v11
v_dot2c_f32_bf16 v60, v94, v11
v_dot2c_f32_bf16 v62, v95, v11
v_dot2c_f32_bf16 v57, v92, v4
v_dot2c_f32_bf16 v59, v93, v4
v_dot2c_f32_bf16 v61, v94, v4
v_dot2c_f32_bf16 v63, v95, v4
ds_read_b128 v[8:11], v14 offset:9232
s_waitcnt lgkmcnt(0)
v_lshlrev_b32 v4, 16, v8
v_dot2c_f32_bf16 v48, v96, v8
v_dot2c_f32_bf16 v50, v97, v8
v_dot2c_f32_bf16 v52, v98, v8
v_dot2c_f32_bf16 v54, v99, v8
v_dot2c_f32_bf16 v49, v96, v4
v_dot2c_f32_bf16 v51, v97, v4
v_dot2c_f32_bf16 v53, v98, v4
v_dot2c_f32_bf16 v55, v99, v4
v_dot2c_f32_bf16 v56, v100, v8
v_dot2c_f32_bf16 v58, v101, v8
v_dot2c_f32_bf16 v60, v102, v8
v_dot2c_f32_bf16 v62, v103, v8
v_dot2c_f32_bf16 v57, v100, v4
v_dot2c_f32_bf16 v59, v101, v4
v_dot2c_f32_bf16 v61, v102, v4
v_dot2c_f32_bf16 v63, v103, v4
v_lshlrev_b32 v4, 16, v9
v_dot2c_f32_bf16 v48, v104, v9
v_dot2c_f32_bf16 v50, v105, v9
v_dot2c_f32_bf16 v52, v106, v9
v_dot2c_f32_bf16 v54, v107, v9
v_dot2c_f32_bf16 v49, v104, v4
v_dot2c_f32_bf16 v51, v105, v4
v_dot2c_f32_bf16 v53, v106, v4
v_dot2c_f32_bf16 v55, v107, v4
v_dot2c_f32_bf16 v56, v108, v9
v_dot2c_f32_bf16 v58, v109, v9
v_dot2c_f32_bf16 v60, v110, v9
v_dot2c_f32_bf16 v62, v111, v9
v_dot2c_f32_bf16 v57, v108, v4
v_dot2c_f32_bf16 v59, v109, v4
v_dot2c_f32_bf16 v61, v110, v4
v_dot2c_f32_bf16 v63, v111, v4
v_lshlrev_b32 v4, 16, v10
v_dot2c_f32_bf16 v48, v112, v10
v_dot2c_f32_bf16 v50, v113, v10
v_dot2c_f32_bf16 v52, v114, v10
v_dot2c_f32_bf16 v54, v115, v10
v_dot2c_f32_bf16 v49, v112, v4
v_dot2c_f32_bf16 v51, v113, v4
v_dot2c_f32_bf16 v53, v114, v4
v_dot2c_f32_bf16 v55, v115, v4
v_dot2c_f32_bf16 v56, v116, v10
v_dot2c_f32_bf16 v58, v117, v10
v_dot2c_f32_bf16 v60, v118, v10
v_dot2c_f32_bf16 v62, v119, v10
v_dot2c_f32_bf16 v57, v116, v4
v_dot2c_f32_bf16 v59, v117, v4
v_dot2c_f32_bf16 v61, v118, v4
v_dot2c_f32_bf16 v63, v119, v4
v_lshlrev_b32 v4, 16, v11
v_dot2c_f32_bf16 v48, v120, v11
v_dot2c_f32_bf16 v50, v121, v11
v_dot2c_f32_bf16 v52, v122, v11
v_dot2c_f32_bf16 v54, v123, v11
v_dot2c_f32_bf16 v49, v120, v4
v_dot2c_f32_bf16 v51, v121, v4
v_dot2c_f32_bf16 v53, v122, v4
v_dot2c_f32_bf16 v55, v123, v4
v_dot2c_f32_bf16 v56, v124, v11
v_dot2c_f32_bf16 v58, v125, v11
v_dot2c_f32_bf16 v60, v126, v11
v_dot2c_f32_bf16 v62, v127, v11
v_dot2c_f32_bf16 v57, v124, v4
v_dot2c_f32_bf16 v59, v125, v4
v_dot2c_f32_bf16 v61, v126, v4
v_dot2c_f32_bf16 v63, v127, v4
s_nop 2
v_permlane32_swap_b32 v48, v52
v_permlane32_swap_b32 v49, v53
v_permlane32_swap_b32 v50, v54
v_permlane32_swap_b32 v51, v55
v_add_f32 v48, v48, v52
v_add_f32 v49, v49, v53
v_add_f32 v50, v50, v54
v_add_f32 v51, v51, v55
s_nop 0
v_permlane16_swap_b32 v48, v50
v_permlane16_swap_b32 v49, v51
v_add_f32 v48, v48, v50
v_add_f32 v49, v49, v51
s_nop 0
v_add_f32_dpp v48, v48, v48 row_ror:8 row_mask:0xf bank_mask:0xf
v_add_f32_dpp v49, v49, v49 row_ror:8 row_mask:0xf bank_mask:0xf
ds_write_b64 v13, v[48:49] offset:19456
s_nop 2
v_permlane32_swap_b32 v56, v60
v_permlane32_swap_b32 v57, v61
v_permlane32_swap_b32 v58, v62
v_permlane32_swap_b32 v59, v63
v_add_f32 v56, v56, v60
v_add_f32 v57, v57, v61
v_add_f32 v58, v58, v62
v_add_f32 v59, v59, v63
s_nop 0
v_permlane16_swap_b32 v56, v58
v_permlane16_swap_b32 v57, v59
v_add_f32 v56, v56, v58
v_add_f32 v57, v57, v59
s_nop 0
v_add_f32_dpp v56, v56, v56 row_ror:8 row_mask:0xf bank_mask:0xf
v_add_f32_dpp v57, v57, v57 row_ror:8 row_mask:0xf bank_mask:0xf
ds_write_b64 v13, v[56:57] offset:19712
s_nop 0
SP36:
ds_read_b32 v4, v1 offset:12
s_waitcnt lgkmcnt(0)
v_readfirstlane_b32 s40, v4
s_sub_u32 s43, s43, 1
s_cbranch_scc1 EXIT
s_cmp_ge_u32 s40, 4
s_cbranch_scc1 SD37
s_branch SP36
SD37:
ds_read_b128 v[8:11], v14 offset:7168
s_waitcnt lgkmcnt(0)
v_lshlrev_b32 v4, 16, v8
v_dot2c_f32_bf16 v16, v64, v8
v_dot2c_f32_bf16 v18, v65, v8
v_dot2c_f32_bf16 v20, v66, v8
v_dot2c_f32_bf16 v22, v67, v8
v_dot2c_f32_bf16 v17, v64, v4
v_dot2c_f32_bf16 v19, v65, v4
v_dot2c_f32_bf16 v21, v66, v4
v_dot2c_f32_bf16 v23, v67, v4
v_dot2c_f32_bf16 v24, v68, v8
v_dot2c_f32_bf16 v26, v69, v8
v_dot2c_f32_bf16 v28, v70, v8
v_dot2c_f32_bf16 v30, v71, v8
v_dot2c_f32_bf16 v25, v68, v4
v_dot2c_f32_bf16 v27, v69, v4
v_dot2c_f32_bf16 v29, v70, v4
v_dot2c_f32_bf16 v31, v71, v4
v_lshlrev_b32 v4, 16, v9
v_dot2c_f32_bf16 v16, v72, v9
v_dot2c_f32_bf16 v18, v73, v9
v_dot2c_f32_bf16 v20, v74, v9
v_dot2c_f32_bf16 v22, v75, v9
v_dot2c_f32_bf16 v17, v72, v4
v_dot2c_f32_bf16 v19, v73, v4
v_dot2c_f32_bf16 v21, v74, v4
v_dot2c_f32_bf16 v23, v75, v4
v_dot2c_f32_bf16 v24, v76, v9
v_dot2c_f32_bf16 v26, v77, v9
v_dot2c_f32_bf16 v28, v78, v9
v_dot2c_f32_bf16 v30, v79, v9
v_dot2c_f32_bf16 v25, v76, v4
v_dot2c_f32_bf16 v27, v77, v4
v_dot2c_f32_bf16 v29, v78, v4
v_dot2c_f32_bf16 v31, v79, v4
v_lshlrev_b32 v4, 16, v10
v_dot2c_f32_bf16 v16, v80, v10
v_dot2c_f32_bf16 v18, v81, v10
v_dot2c_f32_bf16 v20, v82, v10
v_dot2c_f32_bf16 v22, v83, v10
v_dot2c_f32_bf16 v17, v80, v4
v_dot2c_f32_bf16 v19, v81, v4
v_dot2c_f32_bf16 v21, v82, v4
v_dot2c_f32_bf16 v23, v83, v4
v_dot2c_f32_bf16 v24, v84, v10
v_dot2c_f32_bf16 v26, v85, v10
v_dot2c_f32_bf16 v28, v86, v10
v_dot2c_f32_bf16 v30, v87, v10
v_dot2c_f32_bf16 v25, v84, v4
v_dot2c_f32_bf16 v27, v85, v4
v_dot2c_f32_bf16 v29, v86, v4
v_dot2c_f32_bf16 v31, v87, v4
v_lshlrev_b32 v4, 16, v11
v_dot2c_f32_bf16 v16, v88, v11
v_dot2c_f32_bf16 v18, v89, v11
v_dot2c_f32_bf16 v20, v90, v11
v_dot2c_f32_bf16 v22, v91, v11
v_dot2c_f32_bf16 v17, v88, v4
v_dot2c_f32_bf16 v19, v89, v4
v_dot2c_f32_bf16 v21, v90, v4
v_dot2c_f32_bf16 v23, v91, v4
v_dot2c_f32_bf16 v24, v92, v11
v_dot2c_f32_bf16 v26, v93, v11
v_dot2c_f32_bf16 v28, v94, v11
v_dot2c_f32_bf16 v30, v95, v11
v_dot2c_f32_bf16 v25, v92, v4
v_dot2c_f32_bf16 v27, v93, v4
v_dot2c_f32_bf16 v29, v94, v4
v_dot2c_f32_bf16 v31, v95, v4
ds_read_b128 v[8:11], v14 offset:7184
s_waitcnt lgkmcnt(0)
v_lshlrev_b32 v4, 16, v8
v_dot2c_f32_bf16 v16, v96, v8
v_dot2c_f32_bf16 v18, v97, v8
v_dot2c_f32_bf16 v20, v98, v8
v_dot2c_f32_bf16 v22, v99, v8
v_dot2c_f32_bf16 v17, v96, v4
v_dot2c_f32_bf16 v19, v97, v4
v_dot2c_f32_bf16 v21, v98, v4
v_dot2c_f32_bf16 v23, v99, v4
v_dot2c_f32_bf16 v24, v100, v8
v_dot2c_f32_bf16 v26, v101, v8
v_dot2c_f32_bf16 v28, v102, v8
v_dot2c_f32_bf16 v30, v103, v8
v_dot2c_f32_bf16 v25, v100, v4
v_dot2c_f32_bf16 v27, v101, v4
v_dot2c_f32_bf16 v29, v102, v4
v_dot2c_f32_bf16 v31, v103, v4
v_lshlrev_b32 v4, 16, v9
v_dot2c_f32_bf16 v16, v104, v9
v_dot2c_f32_bf16 v18, v105, v9
v_dot2c_f32_bf16 v20, v106, v9
v_dot2c_f32_bf16 v22, v107, v9
v_dot2c_f32_bf16 v17, v104, v4
v_dot2c_f32_bf16 v19, v105, v4
v_dot2c_f32_bf16 v21, v106, v4
v_dot2c_f32_bf16 v23, v107, v4
v_dot2c_f32_bf16 v24, v108, v9
v_dot2c_f32_bf16 v26, v109, v9
v_dot2c_f32_bf16 v28, v110, v9
v_dot2c_f32_bf16 v30, v111, v9
v_dot2c_f32_bf16 v25, v108, v4
v_dot2c_f32_bf16 v27, v109, v4
v_dot2c_f32_bf16 v29, v110, v4
v_dot2c_f32_bf16 v31, v111, v4
v_lshlrev_b32 v4, 16, v10
v_dot2c_f32_bf16 v16, v112, v10
v_dot2c_f32_bf16 v18, v113, v10
v_dot2c_f32_bf16 v20, v114, v10
v_dot2c_f32_bf16 v22, v115, v10
v_dot2c_f32_bf16 v17, v112, v4
v_dot2c_f32_bf16 v19, v113, v4
v_dot2c_f32_bf16 v21, v114, v4
v_dot2c_f32_bf16 v23, v115, v4
v_dot2c_f32_bf16 v24, v116, v10
v_dot2c_f32_bf16 v26, v117, v10
v_dot2c_f32_bf16 v28, v118, v10
v_dot2c_f32_bf16 v30, v119, v10
v_dot2c_f32_bf16 v25, v116, v4
v_dot2c_f32_bf16 v27, v117, v4
v_dot2c_f32_bf16 v29, v118, v4
v_dot2c_f32_bf16 v31, v119, v4
v_lshlrev_b32 v4, 16, v11
v_dot2c_f32_bf16 v16, v120, v11
v_dot2c_f32_bf16 v18, v121, v11
v_dot2c_f32_bf16 v20, v122, v11
v_dot2c_f32_bf16 v22, v123, v11
v_dot2c_f32_bf16 v17, v120, v4
v_dot2c_f32_bf16 v19, v121, v4
v_dot2c_f32_bf16 v21, v122, v4
v_dot2c_f32_bf16 v23, v123, v4
v_dot2c_f32_bf16 v24, v124, v11
v_dot2c_f32_bf16 v26, v125, v11
v_dot2c_f32_bf16 v28, v126, v11
v_dot2c_f32_bf16 v30, v127, v11
v_dot2c_f32_bf16 v25, v124, v4
v_dot2c_f32_bf16 v27, v125, v4
v_dot2c_f32_bf16 v29, v126, v4
v_dot2c_f32_bf16 v31, v127, v4
s_nop 2
v_permlane32_swap_b32 v16, v20
v_permlane32_swap_b32 v17, v21
v_permlane32_swap_b32 v18, v22
v_permlane32_swap_b32 v19, v23
v_add_f32 v16, v16, v20
v_add_f32 v17, v17, v21
v_add_f32 v18, v18, v22
v_add_f32 v19, v19, v23
s_nop 0
v_permlane16_swap_b32 v16, v18
v_permlane16_swap_b32 v17, v19
v_add_f32 v16, v16, v18
v_add_f32 v17, v17, v19
s_nop 0
v_add_f32_dpp v16, v16, v16 row_ror:8 row_mask:0xf bank_mask:0xf
v_add_f32_dpp v17, v17, v17 row_ror:8 row_mask:0xf bank_mask:0xf
ds_write_b64 v13, v[16:17] offset:18432
s_nop 2
v_permlane32_swap_b32 v24, v28
v_permlane32_swap_b32 v25, v29
v_permlane32_swap_b32 v26, v30
v_permlane32_swap_b32 v27, v31
v_add_f32 v24, v24, v28
v_add_f32 v25, v25, v29
v_add_f32 v26, v26, v30
v_add_f32 v27, v27, v31
s_nop 0
v_permlane16_swap_b32 v24, v26
v_permlane16_swap_b32 v25, v27
v_add_f32 v24, v24, v26
v_add_f32 v25, v25, v27
s_nop 0
v_add_f32_dpp v24, v24, v24 row_ror:8 row_mask:0xf bank_mask:0xf
v_add_f32_dpp v25, v25, v25 row_ror:8 row_mask:0xf bank_mask:0xf
ds_write_b64 v13, v[24:25] offset:18688
s_mov_b64 exec, 1
ds_add_rtn_u32 v4, v1, v2 offset:76
s_mov_b64 exec, -1
s_waitcnt lgkmcnt(0)
v_readfirstlane_b32 s40, v4
s_cmp_lg_u32 s40, 3
s_cbranch_scc1 LP38
LP38x:
s_mov_b32 exec_lo, 0xffffffff
s_mov_b32 exec_hi, 0xffff
ds_read_b128 v[16:19], v5 offset:18432
ds_read_b128 v[20:23], v5 offset:19968
ds_read_b128 v[24:27], v5 offset:21504
ds_read_b128 v[28:31], v5 offset:23040
ds_read_b128 v[32:35], v5 offset:19200
ds_read_b128 v[36:39], v5 offset:20736
ds_read_b128 v[40:43], v5 offset:22272
ds_read_b128 v[44:47], v5 offset:23808
s_waitcnt lgkmcnt(6)
v_add_f32 v16, v16, v20
v_add_f32 v17, v17, v21
v_add_f32 v18, v18, v22
v_add_f32 v19, v19, v23
s_waitcnt lgkmcnt(4)
v_add_f32 v24, v24, v28
v_add_f32 v25, v25, v29
v_add_f32 v26, v26, v30
v_add_f32 v27, v27, v31
v_add_f32 v16, v16, v24
v_add_f32 v17, v17, v25
v_add_f32 v18, v18, v26
v_add_f32 v19, v19, v27
v_and_or_b32 v16, v16, v3, s36
v_and_or_b32 v17, v17, v3, s37
v_and_or_b32 v18, v18, v3, s38
v_and_or_b32 v19, v19, v3, s39
global_store_dwordx4 v15, v[16:19], s[50:51] sc1
s_waitcnt lgkmcnt(2)
v_add_f32 v32, v32, v36
v_add_f32 v33, v33, v37
v_add_f32 v34, v34, v38
v_add_f32 v35, v35, v39
s_waitcnt lgkmcnt(0)
v_add_f32 v40, v40, v44
v_add_f32 v41, v41, v45
v_add_f32 v42, v42, v46
v_add_f32 v43, v43, v47
v_add_f32 v32, v32, v40
v_add_f32 v33, v33, v41
v_add_f32 v34, v34, v42
v_add_f32 v35, v35, v43
v_and_or_b32 v32, v32, v3, s36
v_and_or_b32 v33, v33, v3, s37
v_and_or_b32 v34, v34, v3, s38
v_and_or_b32 v35, v35, v3, s39
global_store_dwordx4 v12, v[32:35], s[50:51] sc1
s_mov_b64 exec, -1
s_mov_b64 exec, 1
ds_add_u32 v1, v2 offset:48
s_mov_b64 exec, -1
LP38:
s_endpgm
G3:
s_setprio 3
v_lshlrev_b32 v8, 2, v0
ds_write_b32 v8, v1
v_and_b32 v12, 15, v0
v_lshrrev_b32 v13, 4, v0
v_lshlrev_b32 v8, 5, v0
global_load_dwordx4 v[16:19], v8, s[4:5]
global_load_dwordx4 v[20:23], v8, s[4:5] offset:16
v_lshl_add_u32 v14, v12, 2, v13
s_lshl_b32 s48, s34, 6
v_add_u32 v14, s48, v14
s_and_b32 s28, s2, 3
s_and_b32 s29, s2, 3
s_lshl_b32 s48, s28, 9
v_lshl_add_u32 v9, v14, 1, s48
global_load_ushort v10, v9, s[4:5]
s_and_b32 s48, s29, 3
s_lshl_b32 s48, s48, 9
v_lshl_add_u32 v15, v14, 1, s48
global_load_ushort v11, v15, s[4:5]
v_lshlrev_b32 v14, 2, v14
s_waitcnt lgkmcnt(0)
s_barrier
s_add_u32 s35, s35, 1
s_and_b32 s36, s35, 0xff
s_bfe_u32 s37, s35, 0x80008
s_bfe_u32 s38, s35, 0x80010
s_lshr_b32 s39, s35, 24
s_waitcnt vmcnt(0)
v_and_b32 v33, 0xffff0000, v16
v_lshlrev_b32 v32, 16, v16
v_and_b32 v35, 0xffff0000, v17
v_lshlrev_b32 v34, 16, v17
v_and_b32 v37, 0xffff0000, v18
v_lshlrev_b32 v36, 16, v18
v_and_b32 v39, 0xffff0000, v19
v_lshlrev_b32 v38, 16, v19
v_and_b32 v41, 0xffff0000, v20
v_lshlrev_b32 v40, 16, v20
v_and_b32 v43, 0xffff0000, v21
v_lshlrev_b32 v42, 16, v21
v_and_b32 v45, 0xffff0000, v22
v_lshlrev_b32 v44, 16, v22
v_and_b32 v47, 0xffff0000, v23
v_lshlrev_b32 v46, 16, v23
v_add_f32 v24, v32, v33
v_add_f32 v24, v24, v34
v_add_f32 v24, v24, v35
v_add_f32 v24, v24, v36
v_add_f32 v24, v24, v37
v_add_f32 v24, v24, v38
v_add_f32 v24, v24, v39
v_add_f32 v24, v24, v40
v_add_f32 v24, v24, v41
v_add_f32 v24, v24, v42
v_add_f32 v24, v24, v43
v_add_f32 v24, v24, v44
v_add_f32 v24, v24, v45
v_add_f32 v24, v24, v46
v_add_f32 v24, v24, v47
s_nop 1
v_add_f32_dpp v24, v24, v24 quad_perm:[1,0,3,2] row_mask:0xf bank_mask:0xf
s_nop 1
v_add_f32_dpp v24, v24, v24 quad_perm:[2,3,0,1] row_mask:0xf bank_mask:0xf
s_nop 1
v_add_f32_dpp v24, v24, v24 row_ror:4 row_mask:0xf bank_mask:0xf
s_nop 1
v_add_f32_dpp v24, v24, v24 row_ror:8 row_mask:0xf bank_mask:0xf
v_mov_b32 v4, v24
s_nop 1
v_permlane16_swap_b32 v24, v4
v_add_f32 v24, v24, v4
v_mov_b32 v4, v24
s_nop 1
v_permlane32_swap_b32 v24, v4
v_add_f32 v24, v24, v4
v_mul_f32 v24, 0x3a800000, v24
v_mov_b32 v25, 0
v_sub_f32 v4, v32, v24
v_fmac_f32 v25, v4, v4
v_sub_f32 v4, v33, v24
v_fmac_f32 v25, v4, v4
v_sub_f32 v4, v34, v24
v_fmac_f32 v25, v4, v4
v_sub_f32 v4, v35, v24
v_fmac_f32 v25, v4, v4
v_sub_f32 v4, v36, v24
v_fmac_f32 v25, v4, v4
v_sub_f32 v4, v37, v24
v_fmac_f32 v25, v4, v4
v_sub_f32 v4, v38, v24
v_fmac_f32 v25, v4, v4
v_sub_f32 v4, v39, v24
v_fmac_f32 v25, v4, v4
v_sub_f32 v4, v40, v24
v_fmac_f32 v25, v4, v4
v_sub_f32 v4, v41, v24
v_fmac_f32 v25, v4, v4
v_sub_f32 v4, v42, v24
v_fmac_f32 v25, v4, v4
v_sub_f32 v4, v43, v24
v_fmac_f32 v25, v4, v4
v_sub_f32 v4, v44, v24
v_fmac_f32 v25, v4, v4
v_sub_f32 v4, v45, v24
v_fmac_f32 v25, v4, v4
v_sub_f32 v4, v46, v24
v_fmac_f32 v25, v4, v4
v_sub_f32 v4, v47, v24
v_fmac_f32 v25, v4, v4
s_nop 1
v_add_f32_dpp v25, v25, v25 quad_perm:[1,0,3,2] row_mask:0xf bank_mask:0xf
s_nop 1
v_add_f32_dpp v25, v25, v25 quad_perm:[2,3,0,1] row_mask:0xf bank_mask:0xf
s_nop 1
v_add_f32_dpp v25, v25, v25 row_ror:4 row_mask:0xf bank_mask:0xf
s_nop 1
v_add_f32_dpp v25, v25, v25 row_ror:8 row_mask:0xf bank_mask:0xf
v_mov_b32 v4, v25
s_nop 1
v_permlane16_swap_b32 v25, v4
v_add_f32 v25, v25, v4
v_mov_b32 v4, v25
s_nop 1
v_permlane32_swap_b32 v25, v4
v_add_f32 v25, v25, v4
v_mul_f32 v25, 0x3a800000, v25
v_cvt_pk_bf16_f32 v24, 0, v24
v_cvt_pk_bf16_f32 v25, 0, v25
v_add_f32 v25, 0x3727c5ac, v25
v_cvt_pk_bf16_f32 v25, 0, v25
v_sqrt_f32 v25, v25
s_nop 0
v_cvt_pk_bf16_f32 v25, 0, v25
v_rcp_f32 v25, v25
v_lshlrev_b32 v10, 16, v10
v_lshlrev_b32 v11, 16, v11
v_sub_f32 v10, v10, v24
v_cvt_pk_bf16_f32 v10, 0, v10
v_mul_f32 v10, v10, v25
v_cvt_pk_bf16_f32 v10, 0, v10
G3D:
s_lshl_b32 s48, s28, 10
s_lshl_b32 s49, s34, 8
s_add_u32 s48, s48, s49
s_add_u32 s48, s48, 4096
s_add_u32 s4, s30, s48
s_addc_u32 s5, s31, 0
s_add_u32 s6, s4, 4352
s_addc_u32 s7, s5, 0
s_add_u32 s8, s4, 8704
s_addc_u32 s9, s5, 0
s_add_u32 s10, s4, 13056
s_addc_u32 s11, s5, 0
v_mul_u32_u24 v16, 17408, v13
v_lshl_add_u32 v16, v12, 4, v16
SP39:
ds_read_b32 v4, v1 offset:28
s_waitcnt lgkmcnt(0)
v_readfirstlane_b32 s40, v4
s_sub_u32 s43, s43, 1
s_cbranch_scc1 EXIT
s_cmp_ge_u32 s40, 1
s_cbranch_scc1 SD40
s_branch SP39
SD40:
s_sleep 20
Z41:
s_mov_b64 s[44:45], -1
s_mov_b64 s[46:47], -1
s_mov_b64 s[48:49], -1
s_mov_b64 s[50:51], -1
s_mov_b32 s33, 0
G42:
s_mov_b64 exec, s[44:45]
global_load_dwordx4 v[32:35], v16, s[4:5] offset:0 sc1
s_mov_b64 exec, s[46:47]
global_load_dwordx4 v[36:39], v16, s[8:9] offset:0 sc1
s_mov_b64 exec, s[48:49]
global_load_dwordx4 v[40:43], v16, s[6:7] offset:0 sc1
s_mov_b64 exec, s[50:51]
global_load_dwordx4 v[44:47], v16, s[10:11] offset:0 sc1
s_mov_b64 exec, -1
s_mov_b64 vcc, 0
s_cmp_eq_u32 s33, 0
s_cbranch_scc1 K47
s_waitcnt vmcnt(0)
K47:
s_mov_b32 s33, 1
s_waitcnt vmcnt(3)
v_perm_b32 v4, v33, v32, s41
v_perm_b32 v6, v35, v34, s42
v_or_b32 v4, v4, v6
v_cmp_ne_u32 s[44:45], s35, v4
s_waitcnt vmcnt(2)
v_perm_b32 v4, v37, v36, s41
v_perm_b32 v6, v39, v38, s42
v_or_b32 v4, v4, v6
v_cmp_ne_u32 s[46:47], s35, v4
s_waitcnt vmcnt(1)
v_perm_b32 v4, v41, v40, s41
v_perm_b32 v6, v43, v42, s42
v_or_b32 v4, v4, v6
v_cmp_ne_u32 s[48:49], s35, v4
s_waitcnt vmcnt(0)
v_perm_b32 v4, v45, v44, s41
v_perm_b32 v6, v47, v46, s42
v_or_b32 v4, v4, v6
v_cmp_ne_u32 s[50:51], s35, v4
s_sub_u32 s43, s43, 64
s_cbranch_scc1 EXIT
s_or_b64 vcc, vcc, s[44:45]
s_or_b64 vcc, vcc, s[46:47]
s_or_b64 vcc, vcc, s[48:49]
s_or_b64 vcc, vcc, s[50:51]
s_cbranch_scc1 G42
G42x:
s_mov_b64 exec, -1
v_add_f32 v32, v32, v36
v_add_f32 v40, v40, v44
v_add_f32 v33, v33, v37
v_add_f32 v41, v41, v45
v_add_f32 v34, v34, v38
v_add_f32 v42, v42, v46
v_add_f32 v35, v35, v39
v_add_f32 v43, v43, v47
s_nop 1
v_permlane32_swap_b32 v32, v34
v_permlane32_swap_b32 v33, v35
v_add_f32 v32, v32, v34
v_add_f32 v33, v33, v35
s_nop 1
v_permlane16_swap_b32 v32, v33
v_add_f32 v32, v32, v33
s_nop 1
v_permlane32_swap_b32 v40, v42
v_permlane32_swap_b32 v41, v43
v_add_f32 v40, v40, v42
v_add_f32 v41, v41, v43
s_nop 1
v_permlane16_swap_b32 v40, v41
v_add_f32 v40, v40, v41
v_cvt_pk_bf16_f32 v32, 0, v32
v_cvt_pk_bf16_f32 v40, 0, v40
v_add_f32 v40, 1.0, v40
v_cvt_pk_bf16_f32 v40, 0, v40
v_mul_f32 v40, v40, v10
v_cvt_pk_bf16_f32 v40, 0, v40
v_add_f32 v40, v40, v32
v_cvt_pk_bf16_f32 v40, v40, 0
ds_write_b32 v14, v40 offset:1024
s_mov_b64 exec, 1
ds_add_u32 v1, v2 offset:0
s_mov_b64 exec, -1
s_lshl_b32 s48, s28, 12
s_lshl_b32 s49, s34, 10
s_add_u32 s48, s48, s49
s_add_u32 s48, s48, 143360
s_add_u32 s4, s30, s48
s_addc_u32 s5, s31, 0
s_add_u32 s6, s4, 16384
s_addc_u32 s7, s5, 0
s_add_u32 s8, s4, 32768
s_addc_u32 s9, s5, 0
s_add_u32 s10, s4, 49152
s_addc_u32 s11, s5, 0
v_lshrrev_b32 v17, 5, v0
s_lshl_b32 s48, s34, 1
v_add_u32 v17, s48, v17
v_mul_u32_u24 v17, 272, v17
v_and_b32 v18, 31, v0
v_lshl_add_u32 v17, v18, 3, v17
SP48:
ds_read_b32 v4, v1 offset:32
s_waitcnt lgkmcnt(0)
v_readfirstlane_b32 s40, v4
s_sub_u32 s43, s43, 1
s_cbranch_scc1 EXIT
s_cmp_ge_u32 s40, 1
s_cbranch_scc1 SD49
s_branch SP48
SD49:
s_sleep 20
Z50:
s_mov_b64 s[44:45], -1
s_mov_b64 s[46:47], -1
s_mov_b64 s[48:49], -1
s_mov_b64 s[50:51], -1
s_mov_b32 s33, 0
G51:
s_mov_b64 exec, s[44:45]
global_load_dwordx4 v[32:35], v5, s[4:5] offset:0 sc1
s_mov_b64 exec, s[46:47]
global_load_dwordx4 v[36:39], v5, s[6:7] offset:0 sc1
s_mov_b64 exec, s[48:49]
global_load_dwordx4 v[40:43], v5, s[8:9] offset:0 sc1
s_mov_b64 exec, s[50:51]
global_load_dwordx4 v[44:47], v5, s[10:11] offset:0 sc1
s_mov_b64 exec, -1
s_mov_b64 vcc, 0
s_cmp_eq_u32 s33, 0
s_cbranch_scc1 K56
s_waitcnt vmcnt(0)
K56:
s_mov_b32 s33, 1
s_waitcnt vmcnt(3)
v_perm_b32 v4, v33, v32, s41
v_perm_b32 v6, v35, v34, s42
v_or_b32 v4, v4, v6
v_cmp_ne_u32 s[44:45], s35, v4
s_waitcnt vmcnt(2)
v_perm_b32 v4, v37, v36, s41
v_perm_b32 v6, v39, v38, s42
v_or_b32 v4, v4, v6
v_cmp_ne_u32 s[46:47], s35, v4
s_waitcnt vmcnt(1)
v_perm_b32 v4, v41, v40, s41
v_perm_b32 v6, v43, v42, s42
v_or_b32 v4, v4, v6
v_cmp_ne_u32 s[48:49], s35, v4
s_waitcnt vmcnt(0)
v_perm_b32 v4, v45, v44, s41
v_perm_b32 v6, v47, v46, s42
v_or_b32 v4, v4, v6
v_cmp_ne_u32 s[50:51], s35, v4
s_sub_u32 s43, s43, 64
s_cbranch_scc1 EXIT
s_or_b64 vcc, vcc, s[44:45]
s_or_b64 vcc, vcc, s[46:47]
s_or_b64 vcc, vcc, s[48:49]
s_or_b64 vcc, vcc, s[50:51]
s_cbranch_scc1 G51
G51x:
s_mov_b64 exec, -1
v_add_f32 v32, v32, v36
v_add_f32 v40, v40, v44
v_add_f32 v33, v33, v37
v_add_f32 v41, v41, v45
v_add_f32 v34, v34, v38
v_add_f32 v42, v42, v46
v_add_f32 v35, v35, v39
v_add_f32 v43, v43, v47
v_add_f32 v32, v32, v40
v_add_f32 v33, v33, v41
v_add_f32 v34, v34, v42
v_add_f32 v35, v35, v43
v_cvt_pk_bf16_f32 v32, v32, v33
v_cvt_pk_bf16_f32 v33, v34, v35
ds_write_b64 v17, v[32:33] offset:2048
s_mov_b64 exec, 1
ds_add_u32 v1, v2 offset:4
s_mov_b64 exec, -1
s_lshr_b32 s48, s2, 6
s_lshl_b32 s48, s48, 3
s_and_b32 s49, s2, 7
s_or_b32 s48, s48, s49
s_mul_i32 s48, s48, 40960
s_add_u32 s48, s48, 2097152
s_add_u32 s12, s30, s48
s_addc_u32 s13, s31, 0
s_lshl_b32 s49, s34, 7
s_add_u32 s4, s12, s49
s_addc_u32 s5, s13, 0
s_add_u32 s6, s4, 10240
s_addc_u32 s7, s5, 0
s_add_u32 s8, s4, 20480
s_addc_u32 s9, s5, 0
s_add_u32 s10, s4, 30720
s_addc_u32 s11, s5, 0
v_lshrrev_b32 v18, 3, v0
v_and_b32 v19, 7, v0
v_mul_u32_u24 v16, 640, v18
v_lshl_add_u32 v16, v19, 4, v16
v_add_u32 v24, 5120, v16
v_mul_u32_u24 v25, 640, v0
v_lshlrev_b32 v18, 2, v18
v_lshl_add_u32 v17, v13, 3, v19
s_lshl_b32 s48, s34, 5
v_add_u32 v17, s48, v17
v_lshlrev_b32 v17, 2, v17
SP57:
ds_read_b32 v4, v1 offset:36
s_waitcnt lgkmcnt(0)
v_readfirstlane_b32 s40, v4
s_sub_u32 s43, s43, 1
s_cbranch_scc1 EXIT
s_cmp_ge_u32 s40, 4
s_cbranch_scc1 SD58
s_branch SP57
SD58:
s_sleep 20
Z59:
s_mov_b64 s[44:45], -1
s_mov_b64 s[46:47], -1
s_mov_b64 s[48:49], -1
s_mov_b64 s[50:51], -1
s_mov_b64 s[52:53], -1
s_mov_b64 s[54:55], -1
s_mov_b64 s[56:57], -1
s_mov_b64 s[58:59], -1
s_mov_b64 s[60:61], -1
s_mov_b32 s33, 0
G60:
s_mov_b64 exec, s[44:45]
global_load_dwordx4 v[28:31], v25, s[12:13] offset:512 sc1
s_mov_b64 exec, s[46:47]
global_load_dwordx4 v[32:35], v16, s[4:5] offset:0 sc1
s_mov_b64 exec, s[48:49]
global_load_dwordx4 v[36:39], v24, s[4:5] offset:0 sc1
s_mov_b64 exec, s[50:51]
global_load_dwordx4 v[40:43], v16, s[6:7] offset:0 sc1
s_mov_b64 exec, s[52:53]
global_load_dwordx4 v[44:47], v24, s[6:7] offset:0 sc1
s_mov_b64 exec, s[54:55]
global_load_dwordx4 v[48:51], v16, s[8:9] offset:0 sc1
s_mov_b64 exec, s[56:57]
global_load_dwordx4 v[52:55], v24, s[8:9] offset:0 sc1
s_mov_b64 exec, s[58:59]
global_load_dwordx4 v[56:59], v16, s[10:11] offset:0 sc1
s_mov_b64 exec, s[60:61]
global_load_dwordx4 v[60:63], v24, s[10:11] offset:0 sc1
s_mov_b64 exec, -1
s_mov_b64 vcc, 0
s_cmp_eq_u32 s33, 0
s_cbranch_scc1 K70
s_waitcnt vmcnt(0)
K70:
s_mov_b32 s33, 1
s_waitcnt vmcnt(8)
v_perm_b32 v4, v29, v28, s41
v_perm_b32 v6, v31, v30, s42
v_or_b32 v4, v4, v6
v_cmp_ne_u32 s[44:45], s35, v4
v_and_b32 v26, v3, v28
v_mov_b32 v27, v26
s_nop 1
v_max_f32_dpp v27, v27, v27 quad_perm:[1,0,3,2] row_mask:0xf bank_mask:0xf
s_nop 1
v_max_f32_dpp v27, v27, v27 quad_perm:[2,3,0,1] row_mask:0xf bank_mask:0xf
s_nop 1
v_max_f32_dpp v27, v27, v27 row_ror:4 row_mask:0xf bank_mask:0xf
s_nop 1
v_max_f32_dpp v27, v27, v27 row_ror:8 row_mask:0xf bank_mask:0xf
v_mov_b32 v4, v27
s_nop 1
v_permlane16_swap_b32 v27, v4
v_max_f32 v27, v27, v4
v_mov_b32 v4, v27
s_nop 1
v_permlane32_swap_b32 v27, v4
v_max_f32 v27, v27, v4
v_sub_f32 v26, v26, v27
v_mul_f32 v26, 0x3fb8aa3b, v26
v_exp_f32 v26, v26
s_nop 0
ds_bpermute_b32 v64, v18, v26 offset:0
ds_bpermute_b32 v65, v18, v26 offset:32
ds_bpermute_b32 v66, v18, v26 offset:64
ds_bpermute_b32 v67, v18, v26 offset:96
ds_bpermute_b32 v68, v18, v26 offset:128
ds_bpermute_b32 v69, v18, v26 offset:160
ds_bpermute_b32 v70, v18, v26 offset:192
ds_bpermute_b32 v71, v18, v26 offset:224
v_mul_f32 v27, v29, v26
s_nop 1
v_add_f32_dpp v27, v27, v27 quad_perm:[1,0,3,2] row_mask:0xf bank_mask:0xf
s_nop 1
v_add_f32_dpp v27, v27, v27 quad_perm:[2,3,0,1] row_mask:0xf bank_mask:0xf
s_nop 1
v_add_f32_dpp v27, v27, v27 row_ror:4 row_mask:0xf bank_mask:0xf
s_nop 1
v_add_f32_dpp v27, v27, v27 row_ror:8 row_mask:0xf bank_mask:0xf
v_mov_b32 v4, v27
s_nop 1
v_permlane16_swap_b32 v27, v4
v_add_f32 v27, v27, v4
v_mov_b32 v4, v27
s_nop 1
v_permlane32_swap_b32 v27, v4
v_add_f32 v27, v27, v4
v_rcp_f32 v27, v27
s_waitcnt vmcnt(7)
v_perm_b32 v4, v33, v32, s41
v_perm_b32 v6, v35, v34, s42
v_or_b32 v4, v4, v6
v_cmp_ne_u32 s[46:47], s35, v4
s_waitcnt vmcnt(6)
v_perm_b32 v4, v37, v36, s41
v_perm_b32 v6, v39, v38, s42
v_or_b32 v4, v4, v6
v_cmp_ne_u32 s[48:49], s35, v4
s_waitcnt vmcnt(5)
v_perm_b32 v4, v41, v40, s41
v_perm_b32 v6, v43, v42, s42
v_or_b32 v4, v4, v6
v_cmp_ne_u32 s[50:51], s35, v4
s_waitcnt vmcnt(4)
v_perm_b32 v4, v45, v44, s41
v_perm_b32 v6, v47, v46, s42
v_or_b32 v4, v4, v6
v_cmp_ne_u32 s[52:53], s35, v4
s_waitcnt vmcnt(3)
v_perm_b32 v4, v49, v48, s41
v_perm_b32 v6, v51, v50, s42
v_or_b32 v4, v4, v6
v_cmp_ne_u32 s[54:55], s35, v4
s_waitcnt vmcnt(2)
v_perm_b32 v4, v53, v52, s41
v_perm_b32 v6, v55, v54, s42
v_or_b32 v4, v4, v6
v_cmp_ne_u32 s[56:57], s35, v4
s_waitcnt vmcnt(1)
v_perm_b32 v4, v57, v56, s41
v_perm_b32 v6, v59, v58, s42
v_or_b32 v4, v4, v6
v_cmp_ne_u32 s[58:59], s35, v4
s_waitcnt vmcnt(0)
v_perm_b32 v4, v61, v60, s41
v_perm_b32 v6, v63, v62, s42
v_or_b32 v4, v4, v6
v_cmp_ne_u32 s[60:61], s35, v4
s_sub_u32 s43, s43, 64
s_cbranch_scc1 EXIT
s_or_b64 vcc, vcc, s[44:45]
s_or_b64 vcc, vcc, s[46:47]
s_or_b64 vcc, vcc, s[48:49]
s_or_b64 vcc, vcc, s[50:51]
s_or_b64 vcc, vcc, s[52:53]
s_or_b64 vcc, vcc, s[54:55]
s_or_b64 vcc, vcc, s[56:57]
s_or_b64 vcc, vcc, s[58:59]
s_or_b64 vcc, vcc, s[60:61]
s_cbranch_scc1 G60
G60x:
s_mov_b64 exec, -1
s_waitcnt lgkmcnt(0)
v_mul_f32 v32, v64, v32
v_mul_f32 v33, v64, v33
v_mul_f32 v34, v64, v34
v_mul_f32 v35, v64, v35
v_mul_f32 v36, v65, v36
v_mul_f32 v37, v65, v37
v_mul_f32 v38, v65, v38
v_mul_f32 v39, v65, v39
v_fmac_f32 v32, v66, v40
v_fmac_f32 v33, v66, v41
v_fmac_f32 v34, v66, v42
v_fmac_f32 v35, v66, v43
v_fmac_f32 v36, v67, v44
v_fmac_f32 v37, v67, v45
v_fmac_f32 v38, v67, v46
v_fmac_f32 v39, v67, v47
v_fmac_f32 v32, v68, v48
v_fmac_f32 v33, v68, v49
v_fmac_f32 v34, v68, v50
v_fmac_f32 v35, v68, v51
v_fmac_f32 v36, v69, v52
v_fmac_f32 v37, v69, v53
v_fmac_f32 v38, v69, v54
v_fmac_f32 v39, v69, v55
v_fmac_f32 v32, v70, v56
v_fmac_f32 v33, v70, v57
v_fmac_f32 v34, v70, v58
v_fmac_f32 v35, v70, v59
v_fmac_f32 v36, v71, v60
v_fmac_f32 v37, v71, v61
v_fmac_f32 v38, v71, v62
v_fmac_f32 v39, v71, v63
v_add_f32 v32, v32, v36
v_add_f32 v33, v33, v37
v_add_f32 v34, v34, v38
v_add_f32 v35, v35, v39
s_nop 1
v_permlane32_swap_b32 v32, v34
v_permlane32_swap_b32 v33, v35
v_add_f32 v32, v32, v34
v_add_f32 v33, v33, v35
s_nop 1
v_permlane16_swap_b32 v32, v33
v_add_f32 v32, v32, v33
s_nop 1
v_add_f32_dpp v32, v32, v32 row_ror:8 row_mask:0xf bank_mask:0xf
v_mul_f32 v32, v32, v27
v_cvt_pk_bf16_f32 v32, v32, 0
ds_write_b32 v17, v32 offset:6144
s_mov_b64 exec, 1
ds_add_u32 v1, v2 offset:8
s_mov_b64 exec, -1
s_cmp_ge_u32 s2, 224
s_cbranch_scc1 G3IDLE
s_lshl_b32 s48, s29, 10
s_lshl_b32 s49, s34, 8
s_add_u32 s48, s48, s49
s_add_u32 s48, s48, 262144
s_add_u32 s4, s30, s48
s_addc_u32 s5, s31, 0
s_add_u32 s6, s4, 34816
s_addc_u32 s7, s5, 0
s_add_u32 s8, s4, 69632
s_addc_u32 s9, s5, 0
s_add_u32 s10, s4, 104448
s_addc_u32 s11, s5, 0
v_mul_u32_u24 v16, 4352, v13
v_lshl_add_u32 v16, v12, 4, v16
v_add_u32 v17, 17408, v16
SP71:
ds_read_b32 v4, v1 offset:20
s_waitcnt lgkmcnt(0)
v_readfirstlane_b32 s40, v4
s_sub_u32 s43, s43, 1
s_cbranch_scc1 EXIT
s_cmp_ge_u32 s40, 4
s_cbranch_scc1 SD72
s_branch SP71
SD72:
ds_read_b32 v22, v14 offset:4352
ds_read_b32 v21, v14 offset:11264
ds_read_b32 v23, v14 offset:8192
SP73:
ds_read_b32 v4, v1 offset:40
s_waitcnt lgkmcnt(0)
v_readfirstlane_b32 s40, v4
s_sub_u32 s43, s43, 1
s_cbranch_scc1 EXIT
s_cmp_ge_u32 s40, 1
s_cbranch_scc1 SD74
s_branch SP73
SD74:
v_lshlrev_b32 v23, 16, v23
s_sleep 20
Z75:
s_mov_b64 s[44:45], -1
s_mov_b64 s[46:47], -1
s_mov_b64 s[48:49], -1
s_mov_b64 s[50:51], -1
s_mov_b64 s[52:53], -1
s_mov_b64 s[54:55], -1
s_mov_b64 s[56:57], -1
s_mov_b64 s[58:59], -1
s_mov_b32 s33, 0
G76:
s_mov_b64 exec, s[44:45]
global_load_dwordx4 v[32:35], v16, s[4:5] offset:0 sc1
s_mov_b64 exec, s[46:47]
global_load_dwordx4 v[36:39], v17, s[4:5] offset:0 sc1
s_mov_b64 exec, s[48:49]
global_load_dwordx4 v[40:43], v16, s[6:7] offset:0 sc1
s_mov_b64 exec, s[50:51]
global_load_dwordx4 v[44:47], v17, s[6:7] offset:0 sc1
s_mov_b64 exec, s[52:53]
global_load_dwordx4 v[48:51], v16, s[8:9] offset:0 sc1
s_mov_b64 exec, s[54:55]
global_load_dwordx4 v[52:55], v17, s[8:9] offset:0 sc1
s_mov_b64 exec, s[56:57]
global_load_dwordx4 v[56:59], v16, s[10:11] offset:0 sc1
s_mov_b64 exec, s[58:59]
global_load_dwordx4 v[60:63], v17, s[10:11] offset:0 sc1
s_mov_b64 exec, -1
s_mov_b64 vcc, 0
s_cmp_eq_u32 s33, 0
s_cbranch_scc1 K85
s_waitcnt vmcnt(0)
K85:
s_mov_b32 s33, 1
s_waitcnt vmcnt(7)
v_perm_b32 v4, v33, v32, s41
v_perm_b32 v6, v35, v34, s42
v_or_b32 v4, v4, v6
v_cmp_ne_u32 s[44:45], s35, v4
s_waitcnt vmcnt(6)
v_perm_b32 v4, v37, v36, s41
v_perm_b32 v6, v39, v38, s42
v_or_b32 v4, v4, v6
v_cmp_ne_u32 s[46:47], s35, v4
s_waitcnt vmcnt(5)
v_perm_b32 v4, v41, v40, s41
v_perm_b32 v6, v43, v42, s42
v_or_b32 v4, v4, v6
v_cmp_ne_u32 s[48:49], s35, v4
s_waitcnt vmcnt(4)
v_perm_b32 v4, v45, v44, s41
v_perm_b32 v6, v47, v46, s42
v_or_b32 v4, v4, v6
v_cmp_ne_u32 s[50:51], s35, v4
s_waitcnt vmcnt(3)
v_perm_b32 v4, v49, v48, s41
v_perm_b32 v6, v51, v50, s42
v_or_b32 v4, v4, v6
v_cmp_ne_u32 s[52:53], s35, v4
s_waitcnt vmcnt(2)
v_perm_b32 v4, v53, v52, s41
v_perm_b32 v6, v55, v54, s42
v_or_b32 v4, v4, v6
v_cmp_ne_u32 s[54:55], s35, v4
s_waitcnt vmcnt(1)
v_perm_b32 v4, v57, v56, s41
v_perm_b32 v6, v59, v58, s42
v_or_b32 v4, v4, v6
v_cmp_ne_u32 s[56:57], s35, v4
s_waitcnt vmcnt(0)
v_perm_b32 v4, v61, v60, s41
v_perm_b32 v6, v63, v62, s42
v_or_b32 v4, v4, v6
v_cmp_ne_u32 s[58:59], s35, v4
s_sub_u32 s43, s43, 64
s_cbranch_scc1 EXIT
s_or_b64 vcc, vcc, s[44:45]
s_or_b64 vcc, vcc, s[46:47]
s_or_b64 vcc, vcc, s[48:49]
s_or_b64 vcc, vcc, s[50:51]
s_or_b64 vcc, vcc, s[52:53]
s_or_b64 vcc, vcc, s[54:55]
s_or_b64 vcc, vcc, s[56:57]
s_or_b64 vcc, vcc, s[58:59]
s_cbranch_scc1 G76
G76x:
s_mov_b64 exec, -1
v_add_f32 v32, v32, v36
v_add_f32 v33, v33, v37
v_add_f32 v34, v34, v38
v_add_f32 v35, v35, v39
v_add_f32 v40, v40, v44
v_add_f32 v41, v41, v45
v_add_f32 v42, v42, v46
v_add_f32 v43, v43, v47
v_add_f32 v48, v48, v52
v_add_f32 v49, v49, v53
v_add_f32 v50, v50, v54
v_add_f32 v51, v51, v55
v_add_f32 v56, v56, v60
v_add_f32 v57, v57, v61
v_add_f32 v58, v58, v62
v_add_f32 v59, v59, v63
v_add_f32 v32, v32, v40
v_add_f32 v48, v48, v56
v_add_f32 v33, v33, v41
v_add_f32 v49, v49, v57
v_add_f32 v34, v34, v42
v_add_f32 v50, v50, v58
v_add_f32 v35, v35, v43
v_add_f32 v51, v51, v59
v_add_f32 v32, v32, v48
v_add_f32 v33, v33, v49
v_add_f32 v34, v34, v50
v_add_f32 v35, v35, v51
s_nop 1
v_permlane32_swap_b32 v32, v34
v_permlane32_swap_b32 v33, v35
v_add_f32 v32, v32, v34
v_add_f32 v33, v33, v35
s_nop 1
v_permlane16_swap_b32 v32, v33
v_add_f32 v32, v32, v33
v_cvt_pk_bf16_f32 v20, 0, v32
v_mul_f32 v20, v20, v22
v_cvt_pk_bf16_f32 v20, 0, v20
v_add_f32 v20, v20, v11
v_cvt_pk_bf16_f32 v20, 0, v20
v_mul_f32 v41, v23, v20
v_cvt_pk_bf16_f32 v41, v41, 0
ds_write_b32 v14, v41 offset:7168
s_mov_b64 exec, 1
ds_add_u32 v1, v2 offset:12
s_mov_b64 exec, -1
s_cmp_ge_u32 s2, 4
s_cbranch_scc1 G3GU0
v_mov_b32 v32, v20
v_mul_f32 v33, v20, v20
v_mov_b32 v34, 0
v_mov_b32 v35, 0
s_nop 1
v_add_f32_dpp v32, v32, v32 quad_perm:[1,0,3,2] row_mask:0xf bank_mask:0xf
s_nop 1
v_add_f32_dpp v32, v32, v32 quad_perm:[2,3,0,1] row_mask:0xf bank_mask:0xf
s_nop 1
v_add_f32_dpp v32, v32, v32 row_ror:4 row_mask:0xf bank_mask:0xf
s_nop 1
v_add_f32_dpp v32, v32, v32 row_ror:8 row_mask:0xf bank_mask:0xf
v_mov_b32 v4, v32
s_nop 1
v_permlane16_swap_b32 v32, v4
v_add_f32 v32, v32, v4
v_mov_b32 v4, v32
s_nop 1
v_permlane32_swap_b32 v32, v4
v_add_f32 v32, v32, v4
s_nop 1
v_add_f32_dpp v33, v33, v33 quad_perm:[1,0,3,2] row_mask:0xf bank_mask:0xf
s_nop 1
v_add_f32_dpp v33, v33, v33 quad_perm:[2,3,0,1] row_mask:0xf bank_mask:0xf
s_nop 1
v_add_f32_dpp v33, v33, v33 row_ror:4 row_mask:0xf bank_mask:0xf
s_nop 1
v_add_f32_dpp v33, v33, v33 row_ror:8 row_mask:0xf bank_mask:0xf
v_mov_b32 v4, v33
s_nop 1
v_permlane16_swap_b32 v33, v4
v_add_f32 v33, v33, v4
v_mov_b32 v4, v33
s_nop 1
v_permlane32_swap_b32 v33, v4
v_add_f32 v33, v33, v4
v_and_or_b32 v32, v32, v3, s36
v_and_or_b32 v33, v33, v3, s37
v_and_or_b32 v34, v34, v3, s38
v_and_or_b32 v35, v35, v3, s39
s_lshl_b32 s48, s29, 9
s_lshl_b32 s49, s34, 7
s_add_u32 s48, s48, s49
s_add_u32 s48, s48, 802816
s_add_u32 s4, s30, s48
s_addc_u32 s5, s31, 0
s_mov_b64 exec, 0xff
global_store_dwordx4 v5, v[32:35], s[4:5] sc1
s_mov_b64 exec, -1
G3GU0:
SP86:
ds_read_b32 v4, v1 offset:48
s_waitcnt lgkmcnt(0)
v_readfirstlane_b32 s40, v4
s_sub_u32 s43, s43, 1
s_cbranch_scc1 EXIT
s_cmp_ge_u32 s40, 1
s_cbranch_scc1 SD87
s_branch SP86
SD87:
s_sleep 20
Z88:
s_branch G3GU
G3IDLE:
s_sleep 80
G3GU:
s_lshr_b32 s48, s2, 7
s_lshl_b32 s48, s48, 3
s_and_b32 s49, s2, 7
s_or_b32 s48, s48, s49
s_mul_i32 s48, s48, 896
s_mul_i32 s49, s34, 224
s_add_u32 s48, s48, s49
s_add_u32 s48, s48, 458752
s_add_u32 s4, s30, s48
s_addc_u32 s5, s31, 0
s_add_u32 s6, s4, 57344
s_addc_u32 s7, s5, 0
s_add_u32 s8, s6, 57344
s_addc_u32 s9, s7, 0
s_add_u32 s10, s8, 57344
s_addc_u32 s11, s9, 0
s_add_u32 s12, s10, 57344
s_addc_u32 s13, s11, 0
s_add_u32 s14, s12, 57344
s_addc_u32 s15, s13, 0
s_add_u32 s16, s30, 802816
s_addc_u32 s17, s31, 0
v_mul_u32_u24 v16, 14336, v13
v_min_u32 v17, 13, v12
v_lshl_add_u32 v16, v17, 4, v16
v_lshlrev_b32 v18, 7, v12
v_lshl_add_u32 v17, v17, 2, v13
s_mul_i32 s48, s34, 56
v_add_u32 v17, s48, v17
v_lshlrev_b32 v17, 2, v17
s_mov_b64 s[44:45], -1
s_mov_b64 s[46:47], -1
s_mov_b64 s[48:49], -1
s_mov_b64 s[50:51], -1
s_mov_b64 s[52:53], -1
s_mov_b64 s[54:55], -1
s_mov_b64 s[56:57], -1
s_mov_b32 s33, 0
G89:
s_mov_b64 exec, s[44:45]
global_load_dwordx4 v[28:31], v18, s[16:17] offset:0 sc1
s_mov_b64 exec, s[46:47]
global_load_dwordx4 v[32:35], v16, s[4:5] offset:0 sc1
s_mov_b64 exec, s[48:49]
global_load_dwordx4 v[36:39], v16, s[6:7] offset:0 sc1
s_mov_b64 exec, s[50:51]
global_load_dwordx4 v[40:43], v16, s[8:9] offset:0 sc1
s_mov_b64 exec, s[52:53]
global_load_dwordx4 v[44:47], v16, s[10:11] offset:0 sc1
s_mov_b64 exec, s[54:55]
global_load_dwordx4 v[48:51], v16, s[12:13] offset:0 sc1
s_mov_b64 exec, s[56:57]
global_load_dwordx4 v[52:55], v16, s[14:15] offset:0 sc1
s_mov_b64 exec, -1
s_mov_b64 vcc, 0
s_cmp_eq_u32 s33, 0
s_cbranch_scc1 K97
s_waitcnt vmcnt(0)
K97:
s_mov_b32 s33, 1
s_waitcnt vmcnt(6)
v_perm_b32 v4, v29, v28, s41
v_perm_b32 v6, v31, v30, s42
v_or_b32 v4, v4, v6
v_cmp_ne_u32 s[44:45], s35, v4
v_mov_b32 v26, v28
v_mov_b32 v27, v29
s_nop 0
v_add_f32_dpp v26, v26, v26 quad_perm:[1,0,3,2] row_mask:0xf bank_mask:0xf
v_add_f32_dpp v27, v27, v27 quad_perm:[1,0,3,2] row_mask:0xf bank_mask:0xf
s_nop 0
v_add_f32_dpp v26, v26, v26 quad_perm:[2,3,0,1] row_mask:0xf bank_mask:0xf
v_add_f32_dpp v27, v27, v27 quad_perm:[2,3,0,1] row_mask:0xf bank_mask:0xf
s_nop 0
v_add_f32_dpp v26, v26, v26 row_ror:4 row_mask:0xf bank_mask:0xf
v_add_f32_dpp v27, v27, v27 row_ror:4 row_mask:0xf bank_mask:0xf
s_nop 0
v_add_f32_dpp v26, v26, v26 row_ror:8 row_mask:0xf bank_mask:0xf
v_add_f32_dpp v27, v27, v27 row_ror:8 row_mask:0xf bank_mask:0xf
v_mul_f32 v26, 0x3a800000, v26
v_mul_f32 v27, 0x3a800000, v27
v_fma_f32 v27, -v26, v26, v27
v_add_f32 v27, 0x3727c5ac, v27
v_rsq_f32 v27, v27
s_waitcnt vmcnt(5)
v_perm_b32 v4, v33, v32, s41
v_perm_b32 v6, v35, v34, s42
v_or_b32 v4, v4, v6
v_cmp_ne_u32 s[46:47], s35, v4
s_waitcnt vmcnt(4)
v_perm_b32 v4, v37, v36, s41
v_perm_b32 v6, v39, v38, s42
v_or_b32 v4, v4, v6
v_cmp_ne_u32 s[48:49], s35, v4
s_waitcnt vmcnt(3)
v_perm_b32 v4, v41, v40, s41
v_perm_b32 v6, v43, v42, s42
v_or_b32 v4, v4, v6
v_cmp_ne_u32 s[50:51], s35, v4
s_waitcnt vmcnt(2)
v_perm_b32 v4, v45, v44, s41
v_perm_b32 v6, v47, v46, s42
v_or_b32 v4, v4, v6
v_cmp_ne_u32 s[52:53], s35, v4
s_waitcnt vmcnt(1)
v_perm_b32 v4, v49, v48, s41
v_perm_b32 v6, v51, v50, s42
v_or_b32 v4, v4, v6
v_cmp_ne_u32 s[54:55], s35, v4
s_waitcnt vmcnt(0)
v_perm_b32 v4, v53, v52, s41
v_perm_b32 v6, v55, v54, s42
v_or_b32 v4, v4, v6
v_cmp_ne_u32 s[56:57], s35, v4
s_sub_u32 s43, s43, 64
s_cbranch_scc1 EXIT
s_or_b64 vcc, vcc, s[44:45]
s_or_b64 vcc, vcc, s[46:47]
s_or_b64 vcc, vcc, s[48:49]
s_or_b64 vcc, vcc, s[50:51]
s_or_b64 vcc, vcc, s[52:53]
s_or_b64 vcc, vcc, s[54:55]
s_or_b64 vcc, vcc, s[56:57]
s_cbranch_scc1 G89
G89x:
s_mov_b64 exec, -1
v_fma_f32 v32, -v26, v40, v32
v_fma_f32 v33, -v26, v41, v33
v_fma_f32 v34, -v26, v42, v34
v_fma_f32 v35, -v26, v43, v35
v_fma_f32 v36, -v26, v44, v36
v_fma_f32 v37, -v26, v45, v37
v_fma_f32 v38, -v26, v46, v38
v_fma_f32 v39, -v26, v47, v39
v_fma_f32 v32, v32, v27, v48
v_fma_f32 v33, v33, v27, v49
v_fma_f32 v34, v34, v27, v50
v_fma_f32 v35, v35, v27, v51
v_fma_f32 v36, v36, v27, v52
v_fma_f32 v37, v37, v27, v53
v_fma_f32 v38, v38, v27, v54
v_fma_f32 v39, v39, v27, v55
s_nop 0
v_permlane32_swap_b32 v32, v34
v_permlane32_swap_b32 v36, v38
v_permlane32_swap_b32 v33, v35
v_permlane32_swap_b32 v37, v39
v_add_f32 v32, v32, v34
v_add_f32 v36, v36, v38
v_add_f32 v33, v33, v35
v_add_f32 v37, v37, v39
s_nop 0
v_permlane16_swap_b32 v32, v33
v_permlane16_swap_b32 v36, v37
v_add_f32 v32, v32, v33
v_add_f32 v36, v36, v37
v_cvt_pk_bf16_f32 v32, 0, v32
v_cvt_pk_bf16_f32 v36, 0, v36
v_mul_f32 v33, v32, v32
v_mul_f32 v33, 0x3d372713, v33
v_fma_f32 v33, v33, v32, v32
v_mul_f32 v33, 0xc0135761, v33
v_exp_f32 v33, v33
s_nop 0
v_add_f32 v33, 1.0, v33
v_rcp_f32 v33, v33
s_nop 0
v_mul_f32 v32, v32, v33
v_cvt_pk_bf16_f32 v32, 0, v32
v_mul_f32 v32, v32, v36
v_cvt_pk_bf16_f32 v32, v32, 0
ds_write_b32 v17, v32 offset:10240
s_mov_b64 exec, 1
ds_add_u32 v1, v2 offset:16
s_mov_b64 exec, -1
s_cmp_ge_u32 s2, 4
s_cbranch_scc1 G3END
s_lshl_b32 s48, s29, 10
s_lshl_b32 s49, s34, 8
s_add_u32 s48, s48, s49
s_add_u32 s48, s48, 806912
s_add_u32 s4, s30, s48
s_addc_u32 s5, s31, 0
s_add_u32 s6, s4, 34816
s_addc_u32 s7, s5, 0
v_mul_u32_u24 v16, 4352, v13
v_lshl_add_u32 v16, v12, 4, v16
v_add_u32 v17, 17408, v16
SP98:
ds_read_b32 v4, v1 offset:52
s_waitcnt lgkmcnt(0)
v_readfirstlane_b32 s40, v4
s_sub_u32 s43, s43, 1
s_cbranch_scc1 EXIT
s_cmp_ge_u32 s40, 1
s_cbranch_scc1 SD99
s_branch SP98
SD99:
s_sleep 16
Z100:
s_mov_b64 s[44:45], -1
s_mov_b64 s[46:47], -1
s_mov_b64 s[48:49], -1
s_mov_b64 s[50:51], -1
s_mov_b32 s33, 0
G101:
s_mov_b64 exec, s[44:45]
global_load_dwordx4 v[32:35], v16, s[4:5] offset:0 sc1
s_mov_b64 exec, s[46:47]
global_load_dwordx4 v[36:39], v17, s[4:5] offset:0 sc1
s_mov_b64 exec, s[48:49]
global_load_dwordx4 v[40:43], v16, s[6:7] offset:0 sc1
s_mov_b64 exec, s[50:51]
global_load_dwordx4 v[44:47], v17, s[6:7] offset:0 sc1
s_mov_b64 exec, -1
s_mov_b64 vcc, 0
s_cmp_eq_u32 s33, 0
s_cbranch_scc1 K106
s_waitcnt vmcnt(0)
K106:
s_mov_b32 s33, 1
s_waitcnt vmcnt(3)
v_perm_b32 v4, v33, v32, s41
v_perm_b32 v6, v35, v34, s42
v_or_b32 v4, v4, v6
v_cmp_ne_u32 s[44:45], s35, v4
s_waitcnt vmcnt(2)
v_perm_b32 v4, v37, v36, s41
v_perm_b32 v6, v39, v38, s42
v_or_b32 v4, v4, v6
v_cmp_ne_u32 s[46:47], s35, v4
s_waitcnt vmcnt(1)
v_perm_b32 v4, v41, v40, s41
v_perm_b32 v6, v43, v42, s42
v_or_b32 v4, v4, v6
v_cmp_ne_u32 s[48:49], s35, v4
s_waitcnt vmcnt(0)
v_perm_b32 v4, v45, v44, s41
v_perm_b32 v6, v47, v46, s42
v_or_b32 v4, v4, v6
v_cmp_ne_u32 s[50:51], s35, v4
s_sub_u32 s43, s43, 64
s_cbranch_scc1 EXIT
s_or_b64 vcc, vcc, s[44:45]
s_or_b64 vcc, vcc, s[46:47]
s_or_b64 vcc, vcc, s[48:49]
s_or_b64 vcc, vcc, s[50:51]
s_cbranch_scc1 G101
G101x:
s_mov_b64 exec, -1
v_add_f32 v32, v32, v36
v_add_f32 v40, v40, v44
v_add_f32 v33, v33, v37
v_add_f32 v41, v41, v45
v_add_f32 v34, v34, v38
v_add_f32 v42, v42, v46
v_add_f32 v35, v35, v39
v_add_f32 v43, v43, v47
v_add_f32 v32, v32, v40
v_add_f32 v33, v33, v41
v_add_f32 v34, v34, v42
v_add_f32 v35, v35, v43
s_nop 1
v_permlane32_swap_b32 v32, v34
v_permlane32_swap_b32 v33, v35
v_add_f32 v32, v32, v34
v_add_f32 v33, v33, v35
s_nop 1
v_permlane16_swap_b32 v32, v33
v_add_f32 v32, v32, v33
v_cvt_pk_bf16_f32 v32, 0, v32
v_mul_f32 v32, v32, v21
v_cvt_pk_bf16_f32 v32, 0, v32
v_add_f32 v32, v32, v20
v_cvt_pk_bf16_f32 v32, v32, 0
global_store_short v15, v32, s[26:27]
s_cmp_lg_u32 s2, 0
s_cbranch_scc1 G3END
s_cmp_lg_u32 s34, 0
s_cbranch_scc1 G3END
v_mov_b32 v4, s35
s_mov_b64 exec, 1
global_store_dword v1, v4, s[30:31] sc1
s_mov_b64 exec, -1
G3END:
s_endpgm
EXIT:
s_endpgm
.section .rodata,"a"
.p2align 6
.amdhsa_kernel adaLN_cond__sliding_block_cached__geglu_ffn__decode_kernel
  .amdhsa_next_free_vgpr 128
  .amdhsa_next_free_sgpr 96
  .amdhsa_accum_offset 128
  .amdhsa_group_segment_fixed_size 0
  .amdhsa_kernarg_size 112
  .amdhsa_user_sgpr_count 2
  .amdhsa_user_sgpr_kernarg_segment_ptr 1
  .amdhsa_system_sgpr_workgroup_id_x 1
.end_amdhsa_kernel
```
